```python
import torch

def _softmax(x, axis=-1):
    return torch.softmax(x, dim=axis)

def _gelu(x):
    return torch.nn.functional.gelu(x, approximate='tanh')

def _silu(x):
    return torch.nn.functional.silu(x)

def _sigmoid(x):
    return torch.sigmoid(x)

def _layernorm(x, axis=-1, eps=1e-05):
    m = x.mean(dim=axis, keepdim=True)
    v = x.var(dim=axis, keepdim=True, unbiased=False)
    return (x - m) / torch.sqrt(v + eps)

def _scatter_add(tgt, idx, src, axis=0):
    return tgt.clone().index_add_(axis, idx, src)

def _segment_sum(src, seg, n):
    out = torch.zeros((n,) + src.shape[1:], dtype=src.dtype)
    return out.index_add_(0, seg, src)

def _pad(x, pw):
    flat = tuple((v for pair in reversed(pw) for v in pair))
    return torch.nn.functional.pad(x, flat)
kernel_name = 'adaLN_cond__compressed_kv_cla__glu_gated_glu__decode'

def setup_inputs():

    _w = lambda a: (lambda t: t.to(torch.bfloat16) if t.is_floating_point() else t)(torch.as_tensor(a))

    def _A_setup():
        B, H, Sq, Sk, D, M = (2, 32, 1, 4096, 128, 640)
        Dc = 4 * D
        return {'x': _w((lambda *s: torch.randn(*s, dtype=torch.bfloat16) * 0.05)(B, Sq, M)), 'c_kv': _w((lambda *s: torch.randn(*s, dtype=torch.bfloat16) * 1.6)(B, Sk, Dc)), 'w_q': _w((lambda *s: torch.randn(*s, dtype=torch.bfloat16) * 0.8)(M, H, D) * M ** (-0.5)), 'w_uk': _w((lambda *s: torch.randn(*s, dtype=torch.bfloat16) * 0.8)(Dc, H, D) * Dc ** (-0.5)), 'w_uv': _w((lambda *s: torch.randn(*s, dtype=torch.bfloat16) * 1.6)(Dc, H, D) * Dc ** (-0.5)), 'w_o': _w((lambda *s: torch.randn(*s, dtype=torch.bfloat16) * 1.6)(H, D, M) * (H * D) ** (-0.5))}
    _A_in = _A_setup()

    def _B_setup():
        B, S, D, F = (2, 1, 640, 1728)
        return {'x': _w((lambda *s: torch.randn(*s, dtype=torch.bfloat16) * 0.05)(B, S, D)), 'w_gate': _w((lambda *s: torch.randn(*s, dtype=torch.bfloat16) * 0.05)(D, F)), 'w_up': _w((lambda *s: torch.randn(*s, dtype=torch.bfloat16) * 0.05)(D, F)), 'w_down': _w((lambda *s: torch.randn(*s, dtype=torch.bfloat16) * 0.05)(F, D))}
    _B_in = _B_setup()
    return {'A_x': _A_in['x'], 'A_c_kv': _A_in['c_kv'], 'A_w_q': _A_in['w_q'], 'A_w_uk': _A_in['w_uk'], 'A_w_uv': _A_in['w_uv'], 'A_w_o': _A_in['w_o'], 'B_x': _B_in['x'], 'B_w_gate': _B_in['w_gate'], 'B_w_up': _B_in['w_up'], 'B_w_down': _B_in['w_down'], 'c': _w((lambda *s: torch.randn(*s, dtype=torch.bfloat16) * 0.1)(2, 640) * 8.0), 'w_mod': _w((lambda *s: torch.randn(*s, dtype=torch.bfloat16) * 0.1)(640, 6 * 640) * 640 ** (-0.5) * 8.0)}

def reference(A_x, A_c_kv, A_w_q, A_w_uk, A_w_uv, A_w_o, B_x, B_w_gate, B_w_up, B_w_down, c, w_mod):

    def _A_ref(x, c_kv, w_q, w_uk, w_uv, w_o):
        B, Sq, M = (x.shape[0], x.shape[1], x.shape[2])
        Sk = c_kv.shape[1]
        H, D = (w_q.shape[1], w_q.shape[2])
        q = torch.einsum('bqm,mhd->bhqd', x, w_q)
        k = torch.einsum('bkc,chd->bhkd', c_kv, w_uk)
        v = torch.einsum('bkc,chd->bhkd', c_kv, w_uv)
        scores = torch.einsum('bhqd,bhkd->bhqk', q, k) * D ** (-0.5)
        off = Sk - Sq
        qi = torch.arange(Sq)[:, None]
        kj = torch.arange(Sk)[None, :]
        cmask = kj <= qi + off
        scores = torch.where(cmask[None, None], scores, -1000000000.0)
        p = _softmax(scores, axis=-1)
        ctx = torch.einsum('bhqk,bhkd->bhqd', p, v)
        return torch.einsum('bhqd,hdm->bqm', ctx, w_o)

    def _B_ref(x, w_gate, w_up, w_down):
        g = torch.einsum('bsd,df->bsf', x, w_gate)
        u = torch.einsum('bsd,df->bsf', x, w_up)
        h = _sigmoid(g) * u
        return torch.einsum('bsf,fd->bsd', h, w_down)
    x = A_x
    mod = (_silu(c) @ w_mod).reshape(c.shape[0], 6, 1, -1)
    sa, ca, ga, sb, cb, gb = (mod[:, 0].clone(), mod[:, 1].clone(), mod[:, 2].clone(), mod[:, 3].clone(), mod[:, 4].clone(), mod[:, 5].clone())
    h = _layernorm(x, axis=-1) * (1 + ca) + sa
    x = x + ga * _A_ref(h, A_c_kv, A_w_q, A_w_uk, A_w_uv, A_w_o)
    h = _layernorm(x, axis=-1) * (1 + cb) + sb
    x = x + gb * _B_ref(h, B_w_gate, B_w_up, B_w_down)
    return x
```

```asm
; @launch grid=(256,1,1) block=(512,1,1) lds=142848
.amdgcn_target "amdgcn-amd-amdhsa--gfx950"
.text
.globl adaLN_cond__compressed_kv_cla__glu_gated_glu__decode_kernel
.p2align 8
.type adaLN_cond__compressed_kv_cla__glu_gated_glu__decode_kernel,@function
adaLN_cond__compressed_kv_cla__glu_gated_glu__decode_kernel:
    s_cmp_ge_u32 s2, 256
    s_cbranch_scc1 L_end
    s_mov_b64 s[100:101], -1
    s_lshr_b32 s4, s2, 3
    s_lshl_b32 s4, s4, 2
    s_and_b32 s5, s2, 3
    s_add_u32 s4, s4, s5
    s_bfe_u32 s5, s2, 0x10002
    s_lshl_b32 s5, s5, 7
    s_add_u32 s2, s4, s5
    s_load_dwordx16 s[64:79], s[0:1], 0
    s_load_dwordx8 s[80:87], s[0:1], 64
    s_load_dwordx4 s[88:91], s[0:1], 96
    s_load_dwordx2 s[92:93], s[0:1], 112
    v_lshrrev_b32 v1, 6, v0
    s_nop 0
    v_readfirstlane_b32 s3, v1
    v_and_b32 v1, 63, v0
    v_mov_b32 v2, 0
    v_mov_b32 v3, 0
    v_mov_b32 v4, 0
    v_mov_b32 v5, 0
    v_mov_b32 v6, 0
    v_mov_b32 v7, 0
    v_mov_b32 v8, 0
    v_mov_b32 v9, 0
    v_mov_b32 v10, 0
    v_mov_b32 v11, 0
    v_mov_b32 v12, 0
    s_waitcnt lgkmcnt(0)
    s_load_dwordx2 s[94:95], s[92:93], 0
    s_mov_b32 s8, s92
    s_and_b32 s9, s93, 0xffff
    s_mov_b32 s10, 3145728
    s_mov_b32 s11, 0x00020000
    v_lshrrev_b32 v14, 4, v1
    v_and_b32 v15, 15, v1
    v_lshlrev_b32 v13, 4, v1
    s_cmp_ge_u32 s2, 128
    s_cbranch_scc1 L_de
    s_cmp_ge_u32 s2, 64
    s_cbranch_scc1 L_p3
    s_mov_b32 s12, s64
    s_and_b32 s13, s65, 0xffff
    s_mov_b32 s14, 2560
    s_mov_b32 s15, 0x00020000
    s_mov_b32 s16, s68
    s_and_b32 s17, s69, 0xffff
    s_mov_b32 s18, 5242880
    s_mov_b32 s19, 0x00020000
    s_mov_b32 s20, s70
    s_and_b32 s21, s71, 0xffff
    s_mov_b32 s22, 4194304
    s_mov_b32 s23, 0x00020000
    s_lshr_b32 s40, s2, 1
    s_and_b32 s41, s2, 1
    s_mul_i32 s45, s41, 320
    s_cmp_lg_u32 s3, 7
    s_cbranch_scc1 L_a_init
    v_mov_b32 v4, -1
    v_mov_b32 v5, -1
    v_mov_b32 v6, -1
    v_mov_b32 v7, -1
    s_lshl_b32 s4, s2, 10
    s_add_u32 s4, s4, 131072
    buffer_store_dwordx4 v[4:7], v13, s[8:11], s4 offen sc1
    v_lshrrev_b32 v3, 5, v1
    v_lshlrev_b32 v3, 15, v3
    v_and_b32 v2, 31, v1
    v_lshl_add_u32 v3, v2, 4, v3
    s_lshl_b32 s4, s2, 9
    s_add_u32 s4, s4, 262144
    buffer_store_dwordx4 v[4:7], v3, s[8:11], s4 offen sc1
L_a_w7:
    s_waitcnt vmcnt(0) lgkmcnt(0)
    s_add_u32 s96, s94, 0x7f4a7c15
    s_addc_u32 s97, s95, 0x9e3779b9
    v_mov_b32 v8, s96
    v_mov_b32 v9, s97
    s_lshl_b32 s4, s2, 3
    s_add_u32 s4, s4, 2048
    v_mov_b32 v10, 0
    s_and_b32 exec_lo, s100, 0x1
    s_mov_b32 exec_hi, 0
    buffer_store_dwordx2 v[8:9], v10, s[8:11], s4 offen sc1
    s_mov_b64 exec, s[100:101]
    v_mov_b32 v4, 74752
    v_mov_b32 v5, 0
    v_mov_b32 v6, 0
    v_mov_b32 v7, 0
    ds_write_b64 v4, v[6:7]
    s_waitcnt lgkmcnt(0)
    s_xor_b32 s4, s2, 1
    s_lshl_b32 s4, s4, 3
    s_add_u32 s4, s4, 2048
    v_mov_b32 v2, 0
    s_cbranch_execz L_spin_1_x
    s_mov_b32 s98, 0
L_spin_1:
    buffer_load_dwordx2 v[6:7], v2, s[8:11], s4 offen sc1
    s_waitcnt vmcnt(0)
    v_xor_b32 v6, s96, v6
    v_xor_b32 v7, s97, v7
    v_or_b32 v6, v6, v7
    v_cmp_ne_u32 vcc, 0, v6
    s_cbranch_vccz L_spd_2
    s_add_u32 s98, s98, 1
    s_cmp_gt_u32 s98, 200000
    s_cbranch_scc1 L_end
    s_sleep 2
    s_branch L_spin_1
L_spd_2:
L_spin_1_x:
    s_waitcnt lgkmcnt(0)
    s_branch L_a_main
L_a_init:
    s_cmp_gt_u32 s3, 4
    s_cbranch_scc1 L_a_h1
    v_lshlrev_b32 v2, 17, v14
    v_lshl_add_u32 v2, v15, 4, v2
    s_lshl_b32 s4, s3, 6
    s_add_u32 s4, s4, s45
    s_lshl_b32 s4, s4, 13
    s_lshl_b32 s5, s40, 8
    s_add_u32 s4, s4, s5
    buffer_load_dwordx4 v[20:23], v2, s[16:19], s4 offen nt
    s_add_u32 s4, s4, 8192
    buffer_load_dwordx4 v[24:27], v2, s[16:19], s4 offen nt
    s_add_u32 s4, s4, 8192
    buffer_load_dwordx4 v[28:31], v2, s[16:19], s4 offen nt
    s_add_u32 s4, s4, 8192
    buffer_load_dwordx4 v[32:35], v2, s[16:19], s4 offen nt
    s_add_u32 s4, s4, 8192
    buffer_load_dwordx4 v[36:39], v2, s[16:19], s4 offen nt
    s_add_u32 s4, s4, 8192
    buffer_load_dwordx4 v[40:43], v2, s[16:19], s4 offen nt
    s_add_u32 s4, s4, 8192
    buffer_load_dwordx4 v[44:47], v2, s[16:19], s4 offen nt
    s_add_u32 s4, s4, 8192
    buffer_load_dwordx4 v[48:51], v2, s[16:19], s4 offen nt
    s_add_u32 s4, s4, 8192
    buffer_load_dwordx4 v[52:55], v2, s[16:19], s4 offen nt
    s_add_u32 s4, s4, 8192
    buffer_load_dwordx4 v[56:59], v2, s[16:19], s4 offen nt
    s_add_u32 s4, s4, 8192
    buffer_load_dwordx4 v[60:63], v2, s[16:19], s4 offen nt
    s_add_u32 s4, s4, 8192
    buffer_load_dwordx4 v[64:67], v2, s[16:19], s4 offen nt
    s_add_u32 s4, s4, 8192
    buffer_load_dwordx4 v[68:71], v2, s[16:19], s4 offen nt
    s_add_u32 s4, s4, 8192
    buffer_load_dwordx4 v[72:75], v2, s[16:19], s4 offen nt
    s_add_u32 s4, s4, 8192
    buffer_load_dwordx4 v[76:79], v2, s[16:19], s4 offen nt
    s_add_u32 s4, s4, 8192
    buffer_load_dwordx4 v[80:83], v2, s[16:19], s4 offen nt
    s_cmp_eq_u32 s3, 0
    s_cbranch_scc1 L_w0n_3
    v_add_u32 v3, 0, v14
    v_xor_b32 v3, v3, v15
    v_lshlrev_b32 v3, 4, v3
    v_lshl_add_u32 v6, v14, 13, v3
    v_add_u32 v3, 4, v14
    v_xor_b32 v3, v3, v15
    v_lshlrev_b32 v3, 4, v3
    v_lshl_add_u32 v7, v14, 13, v3
    v_add_u32 v3, 8, v14
    v_xor_b32 v3, v3, v15
    v_lshlrev_b32 v3, 4, v3
    v_lshl_add_u32 v8, v14, 13, v3
    v_add_u32 v3, 12, v14
    v_xor_b32 v3, v3, v15
    v_lshlrev_b32 v3, 4, v3
    v_lshl_add_u32 v9, v14, 13, v3
    s_lshl_b32 s4, s41, 21
    s_lshl_b32 s5, s40, 8
    s_add_u32 s4, s4, s5
    s_sub_u32 s6, s3, 1
    s_mul_i32 s6, s6, 0
    s_add_u32 s6, s6, 0
    s_lshl_b32 s5, s6, 15
    s_add_u32 s4, s4, s5
    s_lshl_b32 s5, s6, 10
L_dmad_4:
    s_waitcnt vmcnt(0)
L_w0n_3:
    s_cmp_lg_u32 s3, 0
    s_cbranch_scc1 L_w0m_5
    s_waitcnt vmcnt(0)
L_w0m_5:
    v_bfe_u32 v2, v1, 2, 2
    v_cmp_gt_u32 vcc, 2, v2
    s_nop 1
    v_cndmask_b32 v3, 0, -1, vcc
    v_and_b32 v2, 3, v1
    v_cmp_eq_u32 vcc, 0, v2
    s_nop 1
    v_cndmask_b32 v16, 0, v3, vcc
    v_cmp_eq_u32 vcc, 1, v2
    s_nop 1
    v_cndmask_b32 v17, 0, v3, vcc
    v_cmp_eq_u32 vcc, 2, v2
    s_nop 1
    v_cndmask_b32 v18, 0, v3, vcc
    v_cmp_eq_u32 vcc, 3, v2
    s_nop 1
    v_cndmask_b32 v19, 0, v3, vcc
    s_waitcnt lgkmcnt(0)
    s_add_u32 s96, s94, 0x7f4a7c15
    s_addc_u32 s97, s95, 0x9e3779b9
    s_mov_b32 s4, 0x05040100
    s_mov_b32 s5, 0x07060302
    v_perm_b32 v4, v24, v20, s4
    v_perm_b32 v24, v24, v20, s5
    v_mov_b32 v20, v4
    v_perm_b32 v5, v25, v21, s4
    v_perm_b32 v25, v25, v21, s5
    v_mov_b32 v21, v5
    v_perm_b32 v4, v26, v22, s4
    v_perm_b32 v26, v26, v22, s5
    v_mov_b32 v22, v4
    v_perm_b32 v5, v27, v23, s4
    v_perm_b32 v27, v27, v23, s5
    v_mov_b32 v23, v5
    v_perm_b32 v4, v32, v28, s4
    v_perm_b32 v32, v32, v28, s5
    v_mov_b32 v28, v4
    v_perm_b32 v5, v33, v29, s4
    v_perm_b32 v33, v33, v29, s5
    v_mov_b32 v29, v5
    v_perm_b32 v4, v34, v30, s4
    v_perm_b32 v34, v34, v30, s5
    v_mov_b32 v30, v4
    v_perm_b32 v5, v35, v31, s4
    v_perm_b32 v35, v35, v31, s5
    v_mov_b32 v31, v5
    v_perm_b32 v4, v40, v36, s4
    v_perm_b32 v40, v40, v36, s5
    v_mov_b32 v36, v4
    v_perm_b32 v5, v41, v37, s4
    v_perm_b32 v41, v41, v37, s5
    v_mov_b32 v37, v5
    v_perm_b32 v4, v42, v38, s4
    v_perm_b32 v42, v42, v38, s5
    v_mov_b32 v38, v4
    v_perm_b32 v5, v43, v39, s4
    v_perm_b32 v43, v43, v39, s5
    v_mov_b32 v39, v5
    v_perm_b32 v4, v48, v44, s4
    v_perm_b32 v48, v48, v44, s5
    v_mov_b32 v44, v4
    v_perm_b32 v5, v49, v45, s4
    v_perm_b32 v49, v49, v45, s5
    v_mov_b32 v45, v5
    v_perm_b32 v4, v50, v46, s4
    v_perm_b32 v50, v50, v46, s5
    v_mov_b32 v46, v4
    v_perm_b32 v5, v51, v47, s4
    v_perm_b32 v51, v51, v47, s5
    v_mov_b32 v47, v5
    v_perm_b32 v4, v56, v52, s4
    v_perm_b32 v56, v56, v52, s5
    v_mov_b32 v52, v4
    v_perm_b32 v5, v57, v53, s4
    v_perm_b32 v57, v57, v53, s5
    v_mov_b32 v53, v5
    v_perm_b32 v4, v58, v54, s4
    v_perm_b32 v58, v58, v54, s5
    v_mov_b32 v54, v4
    v_perm_b32 v5, v59, v55, s4
    v_perm_b32 v59, v59, v55, s5
    v_mov_b32 v55, v5
    v_perm_b32 v4, v64, v60, s4
    v_perm_b32 v64, v64, v60, s5
    v_mov_b32 v60, v4
    v_perm_b32 v5, v65, v61, s4
    v_perm_b32 v65, v65, v61, s5
    v_mov_b32 v61, v5
    v_perm_b32 v4, v66, v62, s4
    v_perm_b32 v66, v66, v62, s5
    v_mov_b32 v62, v4
    v_perm_b32 v5, v67, v63, s4
    v_perm_b32 v67, v67, v63, s5
    v_mov_b32 v63, v5
    v_perm_b32 v4, v72, v68, s4
    v_perm_b32 v72, v72, v68, s5
    v_mov_b32 v68, v4
    v_perm_b32 v5, v73, v69, s4
    v_perm_b32 v73, v73, v69, s5
    v_mov_b32 v69, v5
    v_perm_b32 v4, v74, v70, s4
    v_perm_b32 v74, v74, v70, s5
    v_mov_b32 v70, v4
    v_perm_b32 v5, v75, v71, s4
    v_perm_b32 v75, v75, v71, s5
    v_mov_b32 v71, v5
    v_perm_b32 v4, v80, v76, s4
    v_perm_b32 v80, v80, v76, s5
    v_mov_b32 v76, v4
    v_perm_b32 v5, v81, v77, s4
    v_perm_b32 v81, v81, v77, s5
    v_mov_b32 v77, v5
    v_perm_b32 v4, v82, v78, s4
    v_perm_b32 v82, v82, v78, s5
    v_mov_b32 v78, v4
    v_perm_b32 v5, v83, v79, s4
    v_perm_b32 v83, v83, v79, s5
    v_mov_b32 v79, v5
    s_branch L_a_main
L_a_h1:
    s_sub_u32 s46, s3, 5
    s_mul_i32 s4, s46, 1280
    v_lshlrev_b32 v3, 2, v1
    buffer_load_dword v80, v3, s[12:15], s4 offen offset:0
    buffer_load_dword v81, v3, s[12:15], s4 offen offset:256
    buffer_load_dword v82, v3, s[12:15], s4 offen offset:512
    buffer_load_dword v83, v3, s[12:15], s4 offen offset:768
    buffer_load_dword v84, v3, s[12:15], s4 offen offset:1024
    s_lshl_b32 s5, s45, 1
    s_add_u32 s5, s5, s4
    buffer_load_dwordx4 v[88:91], v13, s[12:15], s5 offen
    s_waitcnt lgkmcnt(0)
    s_add_u32 s96, s94, 0x7f4a7c15
    s_addc_u32 s97, s95, 0x9e3779b9
    s_waitcnt vmcnt(0)
    v_lshlrev_b32 v96, 16, v80
    v_and_b32 v97, 0xffff0000, v80
    v_lshlrev_b32 v98, 16, v81
    v_and_b32 v99, 0xffff0000, v81
    v_lshlrev_b32 v100, 16, v82
    v_and_b32 v101, 0xffff0000, v82
    v_lshlrev_b32 v102, 16, v83
    v_and_b32 v103, 0xffff0000, v83
    v_lshlrev_b32 v104, 16, v84
    v_and_b32 v105, 0xffff0000, v84
    v_add_f32 v92, v96, v97
    v_add_f32 v92, v92, v98
    v_add_f32 v92, v92, v99
    v_add_f32 v92, v92, v100
    v_add_f32 v92, v92, v101
    v_add_f32 v92, v92, v102
    v_add_f32 v92, v92, v103
    v_add_f32 v92, v92, v104
    v_add_f32 v92, v92, v105
    s_nop 1
    v_add_f32_dpp v92, v92, v92 quad_perm:[1,0,3,2] row_mask:0xf bank_mask:0xf
    s_nop 1
    v_add_f32_dpp v92, v92, v92 quad_perm:[2,3,0,1] row_mask:0xf bank_mask:0xf
    s_nop 1
    v_add_f32_dpp v92, v92, v92 row_half_mirror row_mask:0xf bank_mask:0xf
    s_nop 1
    v_add_f32_dpp v92, v92, v92 row_mirror row_mask:0xf bank_mask:0xf
    v_mov_b32 v93, v92
    s_nop 1
    v_permlane16_swap_b32 v92, v93
    s_nop 0
    v_add_f32 v92, v92, v93
    v_mov_b32 v93, v92
    s_nop 1
    v_permlane32_swap_b32 v92, v93
    s_nop 0
    v_add_f32 v92, v92, v93
    v_mul_f32 v92, 0x3acccccd, v92
    v_sub_f32 v96, v96, v92
    v_sub_f32 v97, v97, v92
    v_sub_f32 v98, v98, v92
    v_sub_f32 v99, v99, v92
    v_sub_f32 v100, v100, v92
    v_sub_f32 v101, v101, v92
    v_sub_f32 v102, v102, v92
    v_sub_f32 v103, v103, v92
    v_sub_f32 v104, v104, v92
    v_sub_f32 v105, v105, v92
    v_mul_f32 v94, v96, v96
    v_fmac_f32 v94, v97, v97
    v_fmac_f32 v94, v98, v98
    v_fmac_f32 v94, v99, v99
    v_fmac_f32 v94, v100, v100
    v_fmac_f32 v94, v101, v101
    v_fmac_f32 v94, v102, v102
    v_fmac_f32 v94, v103, v103
    v_fmac_f32 v94, v104, v104
    v_fmac_f32 v94, v105, v105
    s_nop 1
    v_add_f32_dpp v94, v94, v94 quad_perm:[1,0,3,2] row_mask:0xf bank_mask:0xf
    s_nop 1
    v_add_f32_dpp v94, v94, v94 quad_perm:[2,3,0,1] row_mask:0xf bank_mask:0xf
    s_nop 1
    v_add_f32_dpp v94, v94, v94 row_half_mirror row_mask:0xf bank_mask:0xf
    s_nop 1
    v_add_f32_dpp v94, v94, v94 row_mirror row_mask:0xf bank_mask:0xf
    v_mov_b32 v93, v94
    s_nop 1
    v_permlane16_swap_b32 v94, v93
    s_nop 0
    v_add_f32 v94, v94, v93
    v_mov_b32 v93, v94
    s_nop 1
    v_permlane32_swap_b32 v94, v93
    s_nop 0
    v_add_f32 v94, v94, v93
    v_mul_f32 v94, 0x3acccccd, v94
    v_cvt_pk_bf16_f32 v92, v92, v92
    v_and_b32 v92, 0xffff0000, v92
    v_cvt_pk_bf16_f32 v94, v94, v94
    v_and_b32 v94, 0xffff0000, v94
    v_add_f32 v94, 0x3727c5ac, v94
    v_cvt_pk_bf16_f32 v94, v94, v94
    v_and_b32 v94, 0xffff0000, v94
    v_sqrt_f32 v94, v94
    s_nop 0
    v_cvt_pk_bf16_f32 v94, v94, v94
    v_and_b32 v94, 0xffff0000, v94
    v_rcp_f32 v94, v94
    v_lshlrev_b32 v72, 16, v88
    v_and_b32 v73, 0xffff0000, v88
    v_lshlrev_b32 v74, 16, v89
    v_and_b32 v75, 0xffff0000, v89
    v_lshlrev_b32 v76, 16, v90
    v_and_b32 v77, 0xffff0000, v90
    v_lshlrev_b32 v78, 16, v91
    v_and_b32 v79, 0xffff0000, v91
    v_sub_f32 v72, v72, v92
    v_cvt_pk_bf16_f32 v72, v72, v72
    v_and_b32 v72, 0xffff0000, v72
    v_mul_f32 v72, v72, v94
    v_cvt_pk_bf16_f32 v72, v72, v72
    v_and_b32 v72, 0xffff0000, v72
    v_sub_f32 v73, v73, v92
    v_cvt_pk_bf16_f32 v73, v73, v73
    v_and_b32 v73, 0xffff0000, v73
    v_mul_f32 v73, v73, v94
    v_cvt_pk_bf16_f32 v73, v73, v73
    v_and_b32 v73, 0xffff0000, v73
    v_sub_f32 v74, v74, v92
    v_cvt_pk_bf16_f32 v74, v74, v74
    v_and_b32 v74, 0xffff0000, v74
    v_mul_f32 v74, v74, v94
    v_cvt_pk_bf16_f32 v74, v74, v74
    v_and_b32 v74, 0xffff0000, v74
    v_sub_f32 v75, v75, v92
    v_cvt_pk_bf16_f32 v75, v75, v75
    v_and_b32 v75, 0xffff0000, v75
    v_mul_f32 v75, v75, v94
    v_cvt_pk_bf16_f32 v75, v75, v75
    v_and_b32 v75, 0xffff0000, v75
    v_sub_f32 v76, v76, v92
    v_cvt_pk_bf16_f32 v76, v76, v76
    v_and_b32 v76, 0xffff0000, v76
    v_mul_f32 v76, v76, v94
    v_cvt_pk_bf16_f32 v76, v76, v76
    v_and_b32 v76, 0xffff0000, v76
    v_sub_f32 v77, v77, v92
    v_cvt_pk_bf16_f32 v77, v77, v77
    v_and_b32 v77, 0xffff0000, v77
    v_mul_f32 v77, v77, v94
    v_cvt_pk_bf16_f32 v77, v77, v77
    v_and_b32 v77, 0xffff0000, v77
    v_sub_f32 v78, v78, v92
    v_cvt_pk_bf16_f32 v78, v78, v78
    v_and_b32 v78, 0xffff0000, v78
    v_mul_f32 v78, v78, v94
    v_cvt_pk_bf16_f32 v78, v78, v78
    v_and_b32 v78, 0xffff0000, v78
    v_sub_f32 v79, v79, v92
    v_cvt_pk_bf16_f32 v79, v79, v79
    v_and_b32 v79, 0xffff0000, v79
    v_mul_f32 v79, v79, v94
    v_cvt_pk_bf16_f32 v79, v79, v79
    v_and_b32 v79, 0xffff0000, v79
L_a_h1b:
    v_lshlrev_b32 v2, 4, v1
    v_add_u32 v2, 3072, v2
    s_cbranch_execz L_spin_6_x
    s_mov_b32 s98, 0
L_spin_6:
    buffer_load_dwordx4 v[4:7], v2, s[8:11], 0 offen sc1
    s_waitcnt vmcnt(0)
    v_xor_b32 v4, s96, v4
    v_xor_b32 v5, s97, v5
    v_xor_b32 v6, s96, v6
    v_xor_b32 v7, s97, v7
    v_or3_b32 v4, v4, v5, v6
    v_or_b32 v4, v4, v7
    v_cmp_ne_u32 vcc, 0, v4
    s_cbranch_vccz L_spd_7
    s_add_u32 s98, s98, 1
    s_cmp_gt_u32 s98, 200000
    s_cbranch_scc1 L_end
    s_sleep 1
    s_branch L_spin_6
L_spd_7:
L_spin_6_x:
    s_mul_i32 s4, s46, 15360
    s_lshl_b32 s5, s45, 2
    s_add_u32 s4, s4, s5
    s_add_u32 s48, s4, 8192
    s_add_u32 s49, s48, 30720
    s_add_u32 s50, s48, 61440
    s_add_u32 s51, s48, 92160
    v_lshlrev_b32 v2, 5, v1
    s_mul_i32 s4, s46, 640
    s_add_u32 s4, s4, 66560
    v_add_u32 v3, s4, v13
    s_and_b32 exec_lo, s100, 0xffffffff
    s_and_b32 exec_hi, s100, 0xff
    s_cbranch_execz L_spin_8_x
    s_mov_b32 s98, 0
L_spin_8:
    buffer_load_dwordx4 v[96:99], v2, s[8:11], s48 offen sc1
    buffer_load_dwordx4 v[100:103], v2, s[8:11], s48 offen offset:16 sc1
    buffer_load_dwordx4 v[104:107], v2, s[8:11], s48 offen offset:2560 sc1
    buffer_load_dwordx4 v[108:111], v2, s[8:11], s48 offen offset:2576 sc1
    buffer_load_dwordx4 v[112:115], v2, s[8:11], s49 offen sc1
    buffer_load_dwordx4 v[116:119], v2, s[8:11], s49 offen offset:16 sc1
    buffer_load_dwordx4 v[120:123], v2, s[8:11], s49 offen offset:2560 sc1
    buffer_load_dwordx4 v[124:127], v2, s[8:11], s49 offen offset:2576 sc1
    buffer_load_dwordx4 v[128:131], v2, s[8:11], s50 offen sc1
    buffer_load_dwordx4 v[132:135], v2, s[8:11], s50 offen offset:16 sc1
    buffer_load_dwordx4 v[136:139], v2, s[8:11], s50 offen offset:2560 sc1
    buffer_load_dwordx4 v[140:143], v2, s[8:11], s50 offen offset:2576 sc1
    buffer_load_dwordx4 v[144:147], v2, s[8:11], s51 offen sc1
    buffer_load_dwordx4 v[148:151], v2, s[8:11], s51 offen offset:16 sc1
    buffer_load_dwordx4 v[152:155], v2, s[8:11], s51 offen offset:2560 sc1
    buffer_load_dwordx4 v[156:159], v2, s[8:11], s51 offen offset:2576 sc1
    s_waitcnt vmcnt(0)
    v_max3_u32 v12, v96, v97, v98
    v_max3_u32 v12, v12, v99, v100
    v_max3_u32 v12, v12, v101, v102
    v_max3_u32 v12, v12, v103, v104
    v_max3_u32 v12, v12, v105, v106
    v_max3_u32 v12, v12, v107, v108
    v_max3_u32 v12, v12, v109, v110
    v_max3_u32 v12, v12, v111, v112
    v_max3_u32 v12, v12, v113, v114
    v_max3_u32 v12, v12, v115, v116
    v_max3_u32 v12, v12, v117, v118
    v_max3_u32 v12, v12, v119, v120
    v_max3_u32 v12, v12, v121, v122
    v_max3_u32 v12, v12, v123, v124
    v_max3_u32 v12, v12, v125, v126
    v_max3_u32 v12, v12, v127, v128
    v_max3_u32 v12, v12, v129, v130
    v_max3_u32 v12, v12, v131, v132
    v_max3_u32 v12, v12, v133, v134
    v_max3_u32 v12, v12, v135, v136
    v_max3_u32 v12, v12, v137, v138
    v_max3_u32 v12, v12, v139, v140
    v_max3_u32 v12, v12, v141, v142
    v_max3_u32 v12, v12, v143, v144
    v_max3_u32 v12, v12, v145, v146
    v_max3_u32 v12, v12, v147, v148
    v_max3_u32 v12, v12, v149, v150
    v_max3_u32 v12, v12, v151, v152
    v_max3_u32 v12, v12, v153, v154
    v_max3_u32 v12, v12, v155, v156
    v_max3_u32 v12, v12, v157, v158
    v_max_u32 v12, v12, v159
    v_cmp_eq_u32 vcc, -1, v12
    s_cbranch_vccz L_spd_9
    s_add_u32 s98, s98, 1
    s_cmp_gt_u32 s98, 200000
    s_cbranch_scc1 L_end
    s_sleep 1
    s_branch L_spin_8
L_spd_9:
L_spin_8_x:
    v_add_f32 v96, v96, v112
    v_add_f32 v128, v128, v144
    v_add_f32 v96, v96, v128
    v_cvt_pk_bf16_f32 v96, v96, v96
    v_and_b32 v96, 0xffff0000, v96
    v_add_f32 v97, v97, v113
    v_add_f32 v129, v129, v145
    v_add_f32 v97, v97, v129
    v_cvt_pk_bf16_f32 v97, v97, v97
    v_and_b32 v97, 0xffff0000, v97
    v_add_f32 v98, v98, v114
    v_add_f32 v130, v130, v146
    v_add_f32 v98, v98, v130
    v_cvt_pk_bf16_f32 v98, v98, v98
    v_and_b32 v98, 0xffff0000, v98
    v_add_f32 v99, v99, v115
    v_add_f32 v131, v131, v147
    v_add_f32 v99, v99, v131
    v_cvt_pk_bf16_f32 v99, v99, v99
    v_and_b32 v99, 0xffff0000, v99
    v_add_f32 v100, v100, v116
    v_add_f32 v132, v132, v148
    v_add_f32 v100, v100, v132
    v_cvt_pk_bf16_f32 v100, v100, v100
    v_and_b32 v100, 0xffff0000, v100
    v_add_f32 v101, v101, v117
    v_add_f32 v133, v133, v149
    v_add_f32 v101, v101, v133
    v_cvt_pk_bf16_f32 v101, v101, v101
    v_and_b32 v101, 0xffff0000, v101
    v_add_f32 v102, v102, v118
    v_add_f32 v134, v134, v150
    v_add_f32 v102, v102, v134
    v_cvt_pk_bf16_f32 v102, v102, v102
    v_and_b32 v102, 0xffff0000, v102
    v_add_f32 v103, v103, v119
    v_add_f32 v135, v135, v151
    v_add_f32 v103, v103, v135
    v_cvt_pk_bf16_f32 v103, v103, v103
    v_and_b32 v103, 0xffff0000, v103
    v_add_f32 v104, v104, v120
    v_add_f32 v136, v136, v152
    v_add_f32 v104, v104, v136
    v_cvt_pk_bf16_f32 v104, v104, v104
    v_and_b32 v104, 0xffff0000, v104
    v_add_f32 v105, v105, v121
    v_add_f32 v137, v137, v153
    v_add_f32 v105, v105, v137
    v_cvt_pk_bf16_f32 v105, v105, v105
    v_and_b32 v105, 0xffff0000, v105
    v_add_f32 v106, v106, v122
    v_add_f32 v138, v138, v154
    v_add_f32 v106, v106, v138
    v_cvt_pk_bf16_f32 v106, v106, v106
    v_and_b32 v106, 0xffff0000, v106
    v_add_f32 v107, v107, v123
    v_add_f32 v139, v139, v155
    v_add_f32 v107, v107, v139
    v_cvt_pk_bf16_f32 v107, v107, v107
    v_and_b32 v107, 0xffff0000, v107
    v_add_f32 v108, v108, v124
    v_add_f32 v140, v140, v156
    v_add_f32 v108, v108, v140
    v_cvt_pk_bf16_f32 v108, v108, v108
    v_and_b32 v108, 0xffff0000, v108
    v_add_f32 v109, v109, v125
    v_add_f32 v141, v141, v157
    v_add_f32 v109, v109, v141
    v_cvt_pk_bf16_f32 v109, v109, v109
    v_and_b32 v109, 0xffff0000, v109
    v_add_f32 v110, v110, v126
    v_add_f32 v142, v142, v158
    v_add_f32 v110, v110, v142
    v_cvt_pk_bf16_f32 v110, v110, v110
    v_and_b32 v110, 0xffff0000, v110
    v_add_f32 v111, v111, v127
    v_add_f32 v143, v143, v159
    v_add_f32 v111, v111, v143
    v_cvt_pk_bf16_f32 v111, v111, v111
    v_and_b32 v111, 0xffff0000, v111
    v_add_f32 v104, 1.0, v104
    v_cvt_pk_bf16_f32 v104, v104, v104
    v_and_b32 v104, 0xffff0000, v104
    v_mul_f32 v104, v72, v104
    v_cvt_pk_bf16_f32 v104, v104, v104
    v_and_b32 v104, 0xffff0000, v104
    v_add_f32 v104, v104, v96
    v_add_f32 v105, 1.0, v105
    v_cvt_pk_bf16_f32 v105, v105, v105
    v_and_b32 v105, 0xffff0000, v105
    v_mul_f32 v105, v73, v105
    v_cvt_pk_bf16_f32 v105, v105, v105
    v_and_b32 v105, 0xffff0000, v105
    v_add_f32 v105, v105, v97
    v_add_f32 v106, 1.0, v106
    v_cvt_pk_bf16_f32 v106, v106, v106
    v_and_b32 v106, 0xffff0000, v106
    v_mul_f32 v106, v74, v106
    v_cvt_pk_bf16_f32 v106, v106, v106
    v_and_b32 v106, 0xffff0000, v106
    v_add_f32 v106, v106, v98
    v_add_f32 v107, 1.0, v107
    v_cvt_pk_bf16_f32 v107, v107, v107
    v_and_b32 v107, 0xffff0000, v107
    v_mul_f32 v107, v75, v107
    v_cvt_pk_bf16_f32 v107, v107, v107
    v_and_b32 v107, 0xffff0000, v107
    v_add_f32 v107, v107, v99
    v_add_f32 v108, 1.0, v108
    v_cvt_pk_bf16_f32 v108, v108, v108
    v_and_b32 v108, 0xffff0000, v108
    v_mul_f32 v108, v76, v108
    v_cvt_pk_bf16_f32 v108, v108, v108
    v_and_b32 v108, 0xffff0000, v108
    v_add_f32 v108, v108, v100
    v_add_f32 v109, 1.0, v109
    v_cvt_pk_bf16_f32 v109, v109, v109
    v_and_b32 v109, 0xffff0000, v109
    v_mul_f32 v109, v77, v109
    v_cvt_pk_bf16_f32 v109, v109, v109
    v_and_b32 v109, 0xffff0000, v109
    v_add_f32 v109, v109, v101
    v_add_f32 v110, 1.0, v110
    v_cvt_pk_bf16_f32 v110, v110, v110
    v_and_b32 v110, 0xffff0000, v110
    v_mul_f32 v110, v78, v110
    v_cvt_pk_bf16_f32 v110, v110, v110
    v_and_b32 v110, 0xffff0000, v110
    v_add_f32 v110, v110, v102
    v_add_f32 v111, 1.0, v111
    v_cvt_pk_bf16_f32 v111, v111, v111
    v_and_b32 v111, 0xffff0000, v111
    v_mul_f32 v111, v79, v111
    v_cvt_pk_bf16_f32 v111, v111, v111
    v_and_b32 v111, 0xffff0000, v111
    v_add_f32 v111, v111, v103
    v_cvt_pk_bf16_f32 v96, v104, v105
    v_cvt_pk_bf16_f32 v97, v106, v107
    v_cvt_pk_bf16_f32 v98, v108, v109
    v_cvt_pk_bf16_f32 v99, v110, v111
    ds_write_b128 v3, v[96:99]
    s_mov_b64 exec, s[100:101]
    s_waitcnt lgkmcnt(0)
L_a_main:
    s_cmp_eq_u32 s100, 0
    s_cbranch_scc1 L_bar_10
    s_barrier
L_bar_10:
    s_cmp_lg_u32 s3, 6
    s_cselect_b32 s99, s100, 0
    s_cmp_lg_u32 s99, 0
    s_cbranch_scc1 L_nofc_11
    s_waitcnt vmcnt(0) lgkmcnt(0)
    s_add_u32 s96, s94, 0x7f4a7c15
    s_addc_u32 s97, s95, 0x9e3779b9
    v_mov_b32 v8, s96
    v_mov_b32 v9, s97
    s_lshl_b32 s4, s2, 3
    s_add_u32 s4, s4, 6144
    v_mov_b32 v10, 0
    s_and_b32 exec_lo, s100, 0x1
    s_mov_b32 exec_hi, 0
    buffer_store_dwordx2 v[8:9], v10, s[8:11], s4 offen sc1
    s_mov_b64 exec, s[100:101]
L_nofc_11:
    s_cmp_lt_u32 s3, 5
    s_cbranch_scc1 L_w57_13
    v_add_u32 v3, 0, v14
    v_xor_b32 v3, v3, v15
    v_lshlrev_b32 v3, 4, v3
    v_lshl_add_u32 v6, v14, 13, v3
    v_add_u32 v3, 4, v14
    v_xor_b32 v3, v3, v15
    v_lshlrev_b32 v3, 4, v3
    v_lshl_add_u32 v7, v14, 13, v3
    v_add_u32 v3, 8, v14
    v_xor_b32 v3, v3, v15
    v_lshlrev_b32 v3, 4, v3
    v_lshl_add_u32 v8, v14, 13, v3
    v_add_u32 v3, 12, v14
    v_xor_b32 v3, v3, v15
    v_lshlrev_b32 v3, 4, v3
    v_lshl_add_u32 v9, v14, 13, v3
    s_lshl_b32 s4, s41, 21
    s_lshl_b32 s5, s40, 8
    s_add_u32 s4, s4, s5
    s_sub_u32 s6, s3, 5
    s_mul_i32 s6, s6, 24
    s_add_u32 s6, s6, 0
    s_lshl_b32 s5, s6, 15
    s_add_u32 s4, s4, s5
    s_lshl_b32 s5, s6, 10
    s_mov_b32 m0, s5
    s_nop 0
    buffer_load_dwordx4 v6, s[20:23], s4 offen nt lds
    s_add_u32 s4, s4, 32768
    s_add_u32 s5, s5, 1024
    s_mov_b32 m0, s5
    s_nop 0
    buffer_load_dwordx4 v7, s[20:23], s4 offen nt lds
    s_add_u32 s4, s4, 32768
    s_add_u32 s5, s5, 1024
    s_mov_b32 m0, s5
    s_nop 0
    buffer_load_dwordx4 v8, s[20:23], s4 offen nt lds
    s_add_u32 s4, s4, 32768
    s_add_u32 s5, s5, 1024
    s_mov_b32 m0, s5
    s_nop 0
    buffer_load_dwordx4 v9, s[20:23], s4 offen nt lds
    s_add_u32 s4, s4, 32768
    s_add_u32 s5, s5, 1024
    s_mov_b32 m0, s5
    s_nop 0
    buffer_load_dwordx4 v6, s[20:23], s4 offen nt lds
    s_add_u32 s4, s4, 32768
    s_add_u32 s5, s5, 1024
    s_mov_b32 m0, s5
    s_nop 0
    buffer_load_dwordx4 v7, s[20:23], s4 offen nt lds
    s_add_u32 s4, s4, 32768
    s_add_u32 s5, s5, 1024
    s_mov_b32 m0, s5
    s_nop 0
    buffer_load_dwordx4 v8, s[20:23], s4 offen nt lds
    s_add_u32 s4, s4, 32768
    s_add_u32 s5, s5, 1024
    s_mov_b32 m0, s5
    s_nop 0
    buffer_load_dwordx4 v9, s[20:23], s4 offen nt lds
    s_add_u32 s4, s4, 32768
    s_add_u32 s5, s5, 1024
    s_mov_b32 m0, s5
    s_nop 0
    buffer_load_dwordx4 v6, s[20:23], s4 offen nt lds
    s_add_u32 s4, s4, 32768
    s_add_u32 s5, s5, 1024
    s_mov_b32 m0, s5
    s_nop 0
    buffer_load_dwordx4 v7, s[20:23], s4 offen nt lds
    s_add_u32 s4, s4, 32768
    s_add_u32 s5, s5, 1024
    s_mov_b32 m0, s5
    s_nop 0
    buffer_load_dwordx4 v8, s[20:23], s4 offen nt lds
    s_add_u32 s4, s4, 32768
    s_add_u32 s5, s5, 1024
    s_mov_b32 m0, s5
    s_nop 0
    buffer_load_dwordx4 v9, s[20:23], s4 offen nt lds
    s_add_u32 s4, s4, 32768
    s_add_u32 s5, s5, 1024
    s_mov_b32 m0, s5
    s_nop 0
    buffer_load_dwordx4 v6, s[20:23], s4 offen nt lds
    s_add_u32 s4, s4, 32768
    s_add_u32 s5, s5, 1024
    s_mov_b32 m0, s5
    s_nop 0
    buffer_load_dwordx4 v7, s[20:23], s4 offen nt lds
    s_add_u32 s4, s4, 32768
    s_add_u32 s5, s5, 1024
    s_mov_b32 m0, s5
    s_nop 0
    buffer_load_dwordx4 v8, s[20:23], s4 offen nt lds
    s_add_u32 s4, s4, 32768
    s_add_u32 s5, s5, 1024
    s_mov_b32 m0, s5
    s_nop 0
    buffer_load_dwordx4 v9, s[20:23], s4 offen nt lds
    s_add_u32 s4, s4, 32768
    s_add_u32 s5, s5, 1024
    s_cmp_ge_u32 s5, 65536
    s_cbranch_scc1 L_dmad_14
    s_mov_b32 m0, s5
    s_nop 0
    buffer_load_dwordx4 v6, s[20:23], s4 offen nt lds
    s_add_u32 s4, s4, 32768
    s_add_u32 s5, s5, 1024
    s_cmp_ge_u32 s5, 65536
    s_cbranch_scc1 L_dmad_14
    s_mov_b32 m0, s5
    s_nop 0
    buffer_load_dwordx4 v7, s[20:23], s4 offen nt lds
    s_add_u32 s4, s4, 32768
    s_add_u32 s5, s5, 1024
    s_cmp_ge_u32 s5, 65536
    s_cbranch_scc1 L_dmad_14
    s_mov_b32 m0, s5
    s_nop 0
    buffer_load_dwordx4 v8, s[20:23], s4 offen nt lds
    s_add_u32 s4, s4, 32768
    s_add_u32 s5, s5, 1024
    s_cmp_ge_u32 s5, 65536
    s_cbranch_scc1 L_dmad_14
    s_mov_b32 m0, s5
    s_nop 0
    buffer_load_dwordx4 v9, s[20:23], s4 offen nt lds
    s_add_u32 s4, s4, 32768
    s_add_u32 s5, s5, 1024
    s_cmp_ge_u32 s5, 65536
    s_cbranch_scc1 L_dmad_14
    s_mov_b32 m0, s5
    s_nop 0
    buffer_load_dwordx4 v6, s[20:23], s4 offen nt lds
    s_add_u32 s4, s4, 32768
    s_add_u32 s5, s5, 1024
    s_cmp_ge_u32 s5, 65536
    s_cbranch_scc1 L_dmad_14
    s_mov_b32 m0, s5
    s_nop 0
    buffer_load_dwordx4 v7, s[20:23], s4 offen nt lds
    s_add_u32 s4, s4, 32768
    s_add_u32 s5, s5, 1024
    s_cmp_ge_u32 s5, 65536
    s_cbranch_scc1 L_dmad_14
    s_mov_b32 m0, s5
    s_nop 0
    buffer_load_dwordx4 v8, s[20:23], s4 offen nt lds
    s_add_u32 s4, s4, 32768
    s_add_u32 s5, s5, 1024
    s_cmp_ge_u32 s5, 65536
    s_cbranch_scc1 L_dmad_14
    s_mov_b32 m0, s5
    s_nop 0
    buffer_load_dwordx4 v9, s[20:23], s4 offen nt lds
L_dmad_14:
    s_branch L_nop1_12
L_w57_13:
    v_bfe_u32 v2, v1, 2, 1
    v_mul_u32_u24 v2, 640, v2
    v_lshl_add_u32 v2, v14, 5, v2
    s_lshl_b32 s4, s3, 7
    s_add_u32 s4, s4, 66560
    v_add_u32 v2, s4, v2
    ds_read_b128 v[84:87], v2 offset:0
    ds_read_b128 v[88:91], v2 offset:16
    v_lshlrev_b32 v2, 9, v14
    v_lshl_add_u32 v2, v15, 4, v2
    s_lshl_b32 s4, s3, 10
    s_add_u32 s4, s4, 69120
    v_add_u32 v2, s4, v2
    s_waitcnt lgkmcnt(0)
    v_and_b32 v100, v16, v84
    v_and_b32 v101, v17, v84
    v_and_b32 v102, v18, v84
    v_and_b32 v103, v19, v84
    v_and_b32 v104, v16, v85
    v_and_b32 v105, v17, v85
    v_and_b32 v106, v18, v85
    v_and_b32 v107, v19, v85
    v_mfma_f32_16x16x32_bf16 v[108:111], v[100:103], v[20:23], 0
    v_mfma_f32_16x16x32_bf16 v[112:115], v[100:103], v[24:27], 0
    v_and_b32 v100, v16, v86
    v_and_b32 v101, v17, v86
    v_and_b32 v102, v18, v86
    v_and_b32 v103, v19, v86
    v_mfma_f32_16x16x32_bf16 v[108:111], v[104:107], v[28:31], v[108:111]
    v_mfma_f32_16x16x32_bf16 v[112:115], v[104:107], v[32:35], v[112:115]
    v_and_b32 v104, v16, v87
    v_and_b32 v105, v17, v87
    v_and_b32 v106, v18, v87
    v_and_b32 v107, v19, v87
    v_mfma_f32_16x16x32_bf16 v[108:111], v[100:103], v[36:39], v[108:111]
    v_mfma_f32_16x16x32_bf16 v[112:115], v[100:103], v[40:43], v[112:115]
    v_and_b32 v100, v16, v88
    v_and_b32 v101, v17, v88
    v_and_b32 v102, v18, v88
    v_and_b32 v103, v19, v88
    v_mfma_f32_16x16x32_bf16 v[108:111], v[104:107], v[44:47], v[108:111]
    v_mfma_f32_16x16x32_bf16 v[112:115], v[104:107], v[48:51], v[112:115]
    v_and_b32 v104, v16, v89
    v_and_b32 v105, v17, v89
    v_and_b32 v106, v18, v89
    v_and_b32 v107, v19, v89
    v_mfma_f32_16x16x32_bf16 v[108:111], v[100:103], v[52:55], v[108:111]
    v_mfma_f32_16x16x32_bf16 v[112:115], v[100:103], v[56:59], v[112:115]
    v_and_b32 v100, v16, v90
    v_and_b32 v101, v17, v90
    v_and_b32 v102, v18, v90
    v_and_b32 v103, v19, v90
    v_mfma_f32_16x16x32_bf16 v[108:111], v[104:107], v[60:63], v[108:111]
    v_mfma_f32_16x16x32_bf16 v[112:115], v[104:107], v[64:67], v[112:115]
    v_and_b32 v104, v16, v91
    v_and_b32 v105, v17, v91
    v_and_b32 v106, v18, v91
    v_and_b32 v107, v19, v91
    v_mfma_f32_16x16x32_bf16 v[108:111], v[100:103], v[68:71], v[108:111]
    v_mfma_f32_16x16x32_bf16 v[112:115], v[100:103], v[72:75], v[112:115]
    s_nop 1
    v_mfma_f32_16x16x32_bf16 v[108:111], v[104:107], v[76:79], v[108:111]
    v_mfma_f32_16x16x32_bf16 v[112:115], v[104:107], v[80:83], v[112:115]
    s_nop 8
    v_mov_b32 v4, 74756
    v_mov_b32 v5, 1
    s_and_b32 exec_lo, s100, 0xffffffff
    s_mov_b32 exec_hi, 0
    ds_write_b128 v2, v[108:111]
    ds_write_b128 v2, v[112:115] offset:256
    s_and_b32 exec_lo, s100, 0x1
    s_mov_b32 exec_hi, 0
    s_waitcnt lgkmcnt(0)
    ds_add_u32 v4, v5
    s_mov_b64 exec, s[100:101]
L_nop1_12:
    s_cmp_eq_u32 s3, 0
    s_cbranch_scc1 L_w0p_16
    s_waitcnt vmcnt(0)
    v_mov_b32 v4, 74752
    v_mov_b32 v5, 1
    s_and_b32 exec_lo, s100, 0x1
    s_mov_b32 exec_hi, 0
    ds_add_u32 v4, v5
    s_mov_b64 exec, s[100:101]
    s_cbranch_execz L_spin_17_x
    s_mov_b32 s98, 0
L_spin_17:
    ds_read_b32 v5, v4
    s_waitcnt lgkmcnt(0)
    v_cmp_ne_u32 vcc, 7, v5
    s_cbranch_vccz L_spd_18
    s_add_u32 s98, s98, 1
    s_cmp_gt_u32 s98, 200000
    s_cbranch_scc1 L_end
    s_sleep 1
    s_branch L_spin_17
L_spd_18:
L_spin_17_x:
    v_xor_b32 v2, v14, v15
    v_xor_b32 v3, 0, v2
    v_lshlrev_b32 v3, 4, v3
    v_lshl_add_u32 v6, v15, 8, v3
    v_xor_b32 v3, 4, v2
    v_lshlrev_b32 v3, 4, v3
    v_lshl_add_u32 v7, v15, 8, v3
    v_xor_b32 v3, 8, v2
    v_lshlrev_b32 v3, 4, v3
    v_lshl_add_u32 v8, v15, 8, v3
    v_xor_b32 v3, 12, v2
    v_lshlrev_b32 v3, 4, v3
    v_lshl_add_u32 v9, v15, 8, v3
    s_lshl_b32 s4, s3, 13
    v_add_u32 v6, s4, v6
    v_add_u32 v7, s4, v7
    v_add_u32 v8, s4, v8
    v_add_u32 v9, s4, v9
    ds_read_b128 v[20:23], v6 offset:0
    ds_read_b128 v[36:39], v6 offset:4096
    ds_read_b128 v[24:27], v7 offset:0
    ds_read_b128 v[40:43], v7 offset:4096
    ds_read_b128 v[28:31], v8 offset:0
    ds_read_b128 v[44:47], v8 offset:4096
    ds_read_b128 v[32:35], v9 offset:0
    ds_read_b128 v[48:51], v9 offset:4096
    s_branch L_nop1r_15
L_w0p_16:
    s_cbranch_execz L_spin_19_x
    s_mov_b32 s98, 0
L_spin_19:
    ds_read_b32 v5, v4
    s_waitcnt lgkmcnt(0)
    v_cmp_ne_u32 vcc, 5, v5
    s_cbranch_vccz L_spd_20
    s_add_u32 s98, s98, 1
    s_cmp_gt_u32 s98, 200000
    s_cbranch_scc1 L_end
    s_sleep 0
    s_branch L_spin_19
L_spd_20:
L_spin_19_x:
    v_add_u32 v2, 69120, v13
    ds_read_b128 v[164:167], v2 offset:0
    ds_read_b128 v[168:171], v2 offset:1024
    ds_read_b128 v[172:175], v2 offset:2048
    ds_read_b128 v[176:179], v2 offset:3072
    ds_read_b128 v[180:183], v2 offset:4096
    s_lshl_b32 s4, s2, 10
    s_add_u32 s4, s4, 131072
    s_waitcnt lgkmcnt(0)
    v_add_f32 v164, v164, v168
    v_add_f32 v172, v172, v176
    v_add_f32 v164, v164, v180
    v_add_f32 v164, v164, v172
    v_min_u32 v164, 0xfffffffe, v164
    v_add_f32 v165, v165, v169
    v_add_f32 v173, v173, v177
    v_add_f32 v165, v165, v181
    v_add_f32 v165, v165, v173
    v_min_u32 v165, 0xfffffffe, v165
    v_add_f32 v166, v166, v170
    v_add_f32 v174, v174, v178
    v_add_f32 v166, v166, v182
    v_add_f32 v166, v166, v174
    v_min_u32 v166, 0xfffffffe, v166
    v_add_f32 v167, v167, v171
    v_add_f32 v175, v175, v179
    v_add_f32 v167, v167, v183
    v_add_f32 v167, v167, v175
    v_min_u32 v167, 0xfffffffe, v167
    buffer_store_dwordx4 v[164:167], v13, s[8:11], s4 offen sc1
    s_xor_b32 s4, s2, 1
    s_lshl_b32 s4, s4, 10
    s_add_u32 s4, s4, 131072
    s_cbranch_execz L_spin_21_x
    s_mov_b32 s98, 0
L_spin_21:
    buffer_load_dwordx4 v[168:171], v13, s[8:11], s4 offen sc1
    s_waitcnt vmcnt(0)
    v_max3_u32 v2, v168, v169, v170
    v_max_u32 v2, v2, v171
    v_cmp_eq_u32 vcc, -1, v2
    s_cbranch_vccz L_spd_22
    s_add_u32 s98, s98, 1
    s_cmp_gt_u32 s98, 200000
    s_cbranch_scc1 L_end
    s_sleep 1
    s_branch L_spin_21
L_spd_22:
L_spin_21_x:
    v_add_f32 v168, v168, v164
    v_add_f32 v169, v169, v165
    v_add_f32 v170, v170, v166
    v_add_f32 v171, v171, v167
    v_lshrrev_b32 v2, 1, v14
    v_lshlrev_b32 v2, 8, v2
    v_lshl_add_u32 v2, v15, 4, v2
    v_and_b32 v3, 1, v14
    v_lshl_add_u32 v2, v3, 1, v2
    v_add_u32 v2, 74240, v2
    v_cvt_pk_bf16_f32 v168, v168, v168
    ds_write_b16 v2, v168 offset:0
    v_cvt_pk_bf16_f32 v169, v169, v169
    ds_write_b16 v2, v169 offset:4
    v_cvt_pk_bf16_f32 v170, v170, v170
    ds_write_b16 v2, v170 offset:8
    v_cvt_pk_bf16_f32 v171, v171, v171
    ds_write_b16 v2, v171 offset:12
L_nop1r_15:
    s_waitcnt lgkmcnt(0)
    s_cmp_eq_u32 s100, 0
    s_cbranch_scc1 L_bar_23
    s_barrier
L_bar_23:
    v_and_b32 v2, 1, v15
    v_lshlrev_b32 v2, 8, v2
    v_lshl_add_u32 v2, v14, 4, v2
    v_add_u32 v2, 74240, v2
    ds_read_b128 v[164:167], v2 offset:0
    ds_read_b128 v[168:171], v2 offset:64
    ds_read_b128 v[172:175], v2 offset:128
    ds_read_b128 v[176:179], v2 offset:192
    s_cmp_lg_u32 s3, 0
    s_cbranch_scc1 L_w0r_24
    v_xor_b32 v2, v14, v15
    v_xor_b32 v3, 0, v2
    v_lshlrev_b32 v3, 4, v3
    v_lshl_add_u32 v6, v15, 8, v3
    v_xor_b32 v3, 4, v2
    v_lshlrev_b32 v3, 4, v3
    v_lshl_add_u32 v7, v15, 8, v3
    v_xor_b32 v3, 8, v2
    v_lshlrev_b32 v3, 4, v3
    v_lshl_add_u32 v8, v15, 8, v3
    v_xor_b32 v3, 12, v2
    v_lshlrev_b32 v3, 4, v3
    v_lshl_add_u32 v9, v15, 8, v3
    s_lshl_b32 s4, s3, 13
    v_add_u32 v6, s4, v6
    v_add_u32 v7, s4, v7
    v_add_u32 v8, s4, v8
    v_add_u32 v9, s4, v9
    ds_read_b128 v[20:23], v6 offset:0
    ds_read_b128 v[36:39], v6 offset:4096
    ds_read_b128 v[24:27], v7 offset:0
    ds_read_b128 v[40:43], v7 offset:4096
    ds_read_b128 v[28:31], v8 offset:0
    ds_read_b128 v[44:47], v8 offset:4096
    ds_read_b128 v[32:35], v9 offset:0
    ds_read_b128 v[48:51], v9 offset:4096
L_w0r_24:
    v_lshlrev_b32 v2, 15, v15
    v_lshl_add_u32 v2, v14, 3, v2
    s_lshl_b32 s4, s2, 9
    s_lshl_b32 s5, s3, 6
    s_add_u32 s4, s4, s5
    s_add_u32 s4, s4, 262144
    s_mov_b32 s5, 0x3e0293ee
    s_waitcnt lgkmcnt(0)
    v_mfma_f32_16x16x32_bf16 v[180:183], v[20:23], v[164:167], 0
    v_mfma_f32_16x16x32_bf16 v[184:187], v[36:39], v[164:167], 0
    v_mfma_f32_16x16x32_bf16 v[180:183], v[24:27], v[168:171], v[180:183]
    v_mfma_f32_16x16x32_bf16 v[184:187], v[40:43], v[168:171], v[184:187]
    v_mfma_f32_16x16x32_bf16 v[180:183], v[28:31], v[172:175], v[180:183]
    v_mfma_f32_16x16x32_bf16 v[184:187], v[44:47], v[172:175], v[184:187]
    v_mfma_f32_16x16x32_bf16 v[180:183], v[32:35], v[176:179], v[180:183]
    v_mfma_f32_16x16x32_bf16 v[184:187], v[48:51], v[176:179], v[184:187]
    s_nop 8
    v_mul_f32 v180, s5, v180
    v_mul_f32 v181, s5, v181
    v_mul_f32 v182, s5, v182
    v_mul_f32 v183, s5, v183
    v_mul_f32 v184, s5, v184
    v_mul_f32 v185, s5, v185
    v_mul_f32 v186, s5, v186
    v_mul_f32 v187, s5, v187
    v_cvt_pk_bf16_f32 v188, v180, v181
    v_min_u32 v188, 0xfffffffe, v188
    v_cvt_pk_bf16_f32 v189, v182, v183
    v_min_u32 v189, 0xfffffffe, v189
    v_cvt_pk_bf16_f32 v190, v184, v185
    v_min_u32 v190, 0xfffffffe, v190
    v_cvt_pk_bf16_f32 v191, v186, v187
    v_min_u32 v191, 0xfffffffe, v191
    s_and_b32 exec_lo, s100, 0x30003
    s_and_b32 exec_hi, s100, 0x30003
    buffer_store_dwordx2 v[188:189], v2, s[8:11], s4 offen sc1
    buffer_store_dwordx2 v[190:191], v2, s[8:11], s4 offen offset:32 sc1
    s_mov_b64 exec, s[100:101]
    s_cmp_lg_u32 s2, 0
    s_cbranch_scc1 L_end
    s_cmp_lg_u32 s3, 0
    s_cbranch_scc1 L_end
    v_lshlrev_b32 v2, 4, v1
    v_add_u32 v2, 2048, v2
    s_cbranch_execz L_spin_25_x
    s_mov_b32 s98, 0
L_spin_25:
    buffer_load_dwordx4 v[4:7], v2, s[8:11], 0 offen sc1
    buffer_load_dwordx4 v[8:11], v2, s[8:11], 0 offen offset:1024 sc1
    s_waitcnt vmcnt(0)
    v_xor_b32 v4, s96, v4
    v_xor_b32 v5, s97, v5
    v_xor_b32 v6, s96, v6
    v_xor_b32 v7, s97, v7
    v_xor_b32 v8, s96, v8
    v_xor_b32 v9, s97, v9
    v_xor_b32 v10, s96, v10
    v_xor_b32 v11, s97, v11
    v_or3_b32 v4, v4, v5, v6
    v_or3_b32 v4, v4, v7, v8
    v_or3_b32 v4, v4, v9, v10
    v_or_b32 v4, v4, v11
    v_cmp_ne_u32 vcc, 0, v4
    s_cbranch_vccz L_spd_26
    s_add_u32 s98, s98, 1
    s_cmp_gt_u32 s98, 200000
    s_cbranch_scc1 L_end
    s_sleep 1
    s_branch L_spin_25
L_spd_26:
L_spin_25_x:
    v_mov_b32 v10, s96
    v_mov_b32 v11, s97
    v_mov_b32 v12, 0
    s_and_b32 exec_lo, s100, 0x1
    s_mov_b32 exec_hi, 0
    buffer_store_dwordx2 v[10:11], v12, s[8:11], 0 offen sc1
    s_mov_b64 exec, s[100:101]
    s_branch L_end
L_p3:
    s_mov_b32 s12, s66
    s_and_b32 s13, s67, 0xffff
    s_mov_b32 s14, 8388608
    s_mov_b32 s15, 0x00020000
    s_sub_u32 s40, s2, 64
    s_lshr_b32 s42, s40, 5
    s_and_b32 s43, s40, 31
    s_cmp_lg_u32 s3, 7
    s_cbranch_scc1 L_nofa_27
    s_waitcnt vmcnt(0) lgkmcnt(0)
    s_add_u32 s96, s94, 0x7f4a7c15
    s_addc_u32 s97, s95, 0x9e3779b9
    v_mov_b32 v8, s96
    v_mov_b32 v9, s97
    s_lshl_b32 s4, s2, 3
    s_add_u32 s4, s4, 2048
    v_mov_b32 v10, 0
    s_and_b32 exec_lo, s100, 0x1
    s_mov_b32 exec_hi, 0
    buffer_store_dwordx2 v[8:9], v10, s[8:11], s4 offen sc1
    s_mov_b64 exec, s[100:101]
L_nofa_27:
    s_waitcnt lgkmcnt(0)
    s_add_u32 s96, s94, 0x7f4a7c15
    s_addc_u32 s97, s95, 0x9e3779b9
    v_lshlrev_b32 v2, 4, v1
    v_add_u32 v2, 3072, v2
    s_cbranch_execz L_spin_28_x
    s_mov_b32 s98, 0
L_spin_28:
    buffer_load_dwordx4 v[4:7], v2, s[8:11], 0 offen sc1
    s_waitcnt vmcnt(0)
    v_xor_b32 v4, s96, v4
    v_xor_b32 v5, s97, v5
    v_xor_b32 v6, s96, v6
    v_xor_b32 v7, s97, v7
    v_or3_b32 v4, v4, v5, v6
    v_or_b32 v4, v4, v7
    v_cmp_ne_u32 vcc, 0, v4
    s_cbranch_vccz L_spd_29
    s_add_u32 s98, s98, 1
    s_cmp_gt_u32 s98, 200000
    s_cbranch_scc1 L_end
    s_sleep 2
    s_branch L_spin_28
L_spd_29:
L_spin_28_x:
    s_lshl_b32 s4, s40, 17
    s_lshl_b32 s5, s3, 14
    s_add_u32 s4, s4, s5
    s_mul_i32 s5, s3, 16640
    s_mov_b32 m0, s5
    s_nop 0
    buffer_load_dwordx4 v13, s[12:15], s4 offen nt lds
    s_add_u32 s4, s4, 1024
    s_add_u32 s5, s5, 1040
    s_mov_b32 m0, s5
    s_nop 0
    buffer_load_dwordx4 v13, s[12:15], s4 offen nt lds
    s_add_u32 s4, s4, 1024
    s_add_u32 s5, s5, 1040
    s_mov_b32 m0, s5
    s_nop 0
    buffer_load_dwordx4 v13, s[12:15], s4 offen nt lds
    s_add_u32 s4, s4, 1024
    s_add_u32 s5, s5, 1040
    s_mov_b32 m0, s5
    s_nop 0
    buffer_load_dwordx4 v13, s[12:15], s4 offen nt lds
    s_add_u32 s4, s4, 1024
    s_add_u32 s5, s5, 1040
    s_mov_b32 m0, s5
    s_nop 0
    buffer_load_dwordx4 v13, s[12:15], s4 offen nt lds
    s_add_u32 s4, s4, 1024
    s_add_u32 s5, s5, 1040
    s_mov_b32 m0, s5
    s_nop 0
    buffer_load_dwordx4 v13, s[12:15], s4 offen nt lds
    s_add_u32 s4, s4, 1024
    s_add_u32 s5, s5, 1040
    s_mov_b32 m0, s5
    s_nop 0
    buffer_load_dwordx4 v13, s[12:15], s4 offen nt lds
    s_add_u32 s4, s4, 1024
    s_add_u32 s5, s5, 1040
    s_mov_b32 m0, s5
    s_nop 0
    buffer_load_dwordx4 v13, s[12:15], s4 offen nt lds
    s_add_u32 s4, s4, 1024
    s_add_u32 s5, s5, 1040
    s_mov_b32 m0, s5
    s_nop 0
    buffer_load_dwordx4 v13, s[12:15], s4 offen nt lds
    s_add_u32 s4, s4, 1024
    s_add_u32 s5, s5, 1040
    s_mov_b32 m0, s5
    s_nop 0
    buffer_load_dwordx4 v13, s[12:15], s4 offen nt lds
    s_add_u32 s4, s4, 1024
    s_add_u32 s5, s5, 1040
    s_mov_b32 m0, s5
    s_nop 0
    buffer_load_dwordx4 v13, s[12:15], s4 offen nt lds
    s_add_u32 s4, s4, 1024
    s_add_u32 s5, s5, 1040
    s_mov_b32 m0, s5
    s_nop 0
    buffer_load_dwordx4 v13, s[12:15], s4 offen nt lds
    s_add_u32 s4, s4, 1024
    s_add_u32 s5, s5, 1040
    s_mov_b32 m0, s5
    s_nop 0
    buffer_load_dwordx4 v13, s[12:15], s4 offen nt lds
    s_add_u32 s4, s4, 1024
    s_add_u32 s5, s5, 1040
    s_mov_b32 m0, s5
    s_nop 0
    buffer_load_dwordx4 v13, s[12:15], s4 offen nt lds
    s_add_u32 s4, s4, 1024
    s_add_u32 s5, s5, 1040
    s_mov_b32 m0, s5
    s_nop 0
    buffer_load_dwordx4 v13, s[12:15], s4 offen nt lds
    s_add_u32 s4, s4, 1024
    s_add_u32 s5, s5, 1040
    s_mov_b32 m0, s5
    s_nop 0
    buffer_load_dwordx4 v13, s[12:15], s4 offen nt lds
L_p3_real:
    s_waitcnt vmcnt(0)
    s_cmp_eq_u32 s100, 0
    s_cbranch_scc1 L_bar_30
    s_barrier
L_bar_30:
L_p3_main:
    v_mul_u32_u24 v2, 1040, v15
    v_lshl_add_u32 v2, v14, 4, v2
    s_mul_i32 s4, s3, 16640
    v_add_u32 v2, s4, v2
    ds_read_b128 v[20:23], v2 offset:0
    ds_read_b128 v[24:27], v2 offset:64
    ds_read_b128 v[28:31], v2 offset:128
    ds_read_b128 v[32:35], v2 offset:192
    ds_read_b128 v[36:39], v2 offset:256
    ds_read_b128 v[40:43], v2 offset:320
    ds_read_b128 v[44:47], v2 offset:384
    ds_read_b128 v[48:51], v2 offset:448
    ds_read_b128 v[52:55], v2 offset:512
    ds_read_b128 v[56:59], v2 offset:576
    ds_read_b128 v[60:63], v2 offset:640
    ds_read_b128 v[64:67], v2 offset:704
    ds_read_b128 v[68:71], v2 offset:768
    ds_read_b128 v[72:75], v2 offset:832
    ds_read_b128 v[76:79], v2 offset:896
    ds_read_b128 v[80:83], v2 offset:960
    v_lshrrev_b32 v2, 2, v15
    v_lshl_add_u32 v2, v14, 3, v2
    v_mul_u32_u24 v2, 1040, v2
    v_and_b32 v3, 3, v15
    v_lshl_add_u32 v2, v3, 4, v2
    s_lshl_b32 s4, s3, 7
    v_add_u32 v2, s4, v2
    v_add_u32 v3, 66560, v2
    ds_read_b64_tr_b16 v[84:85], v2 offset:0
    ds_read_b64_tr_b16 v[86:87], v2 offset:4160
    ds_read_b64_tr_b16 v[88:89], v2 offset:33280
    ds_read_b64_tr_b16 v[90:91], v2 offset:37440
    ds_read_b64_tr_b16 v[92:93], v3 offset:0
    ds_read_b64_tr_b16 v[94:95], v3 offset:4160
    ds_read_b64_tr_b16 v[96:97], v3 offset:33280
    ds_read_b64_tr_b16 v[98:99], v3 offset:37440
    ds_read_b64_tr_b16 v[100:101], v2 offset:8
    ds_read_b64_tr_b16 v[102:103], v2 offset:4168
    ds_read_b64_tr_b16 v[104:105], v2 offset:33288
    ds_read_b64_tr_b16 v[106:107], v2 offset:37448
    ds_read_b64_tr_b16 v[108:109], v3 offset:8
    ds_read_b64_tr_b16 v[110:111], v3 offset:4168
    ds_read_b64_tr_b16 v[112:113], v3 offset:33288
    ds_read_b64_tr_b16 v[114:115], v3 offset:37448
    ds_read_b64_tr_b16 v[116:117], v2 offset:64
    ds_read_b64_tr_b16 v[118:119], v2 offset:4224
    ds_read_b64_tr_b16 v[120:121], v2 offset:33344
    ds_read_b64_tr_b16 v[122:123], v2 offset:37504
    ds_read_b64_tr_b16 v[124:125], v3 offset:64
    ds_read_b64_tr_b16 v[126:127], v3 offset:4224
    ds_read_b64_tr_b16 v[128:129], v3 offset:33344
    ds_read_b64_tr_b16 v[130:131], v3 offset:37504
    ds_read_b64_tr_b16 v[132:133], v2 offset:72
    ds_read_b64_tr_b16 v[134:135], v2 offset:4232
    ds_read_b64_tr_b16 v[136:137], v2 offset:33352
    ds_read_b64_tr_b16 v[138:139], v2 offset:37512
    ds_read_b64_tr_b16 v[140:141], v3 offset:72
    ds_read_b64_tr_b16 v[142:143], v3 offset:4232
    ds_read_b64_tr_b16 v[144:145], v3 offset:33352
    ds_read_b64_tr_b16 v[146:147], v3 offset:37512
    v_mov_b32 v16, 0x3f803f80
    v_mov_b32 v17, 0x3f803f80
    v_mov_b32 v18, 0x3f803f80
    v_mov_b32 v19, 0x3f803f80
    s_waitcnt lgkmcnt(0)
    s_cmp_lg_u32 s3, 0
    s_cselect_b32 s99, s100, 0
    s_cmp_lg_u32 s99, 0
    s_cbranch_scc1 L_noh2l_31
    v_lshlrev_b32 v2, 4, v1
    v_add_u32 v2, 2048, v2
    s_and_b32 exec_lo, s100, 0xffffffff
    s_mov_b32 exec_hi, 0
    s_cbranch_execz L_spin_32_x
    s_mov_b32 s98, 0
L_spin_32:
    buffer_load_dwordx4 v[4:7], v2, s[8:11], 0 offen sc1
    s_waitcnt vmcnt(0)
    v_xor_b32 v4, s96, v4
    v_xor_b32 v5, s97, v5
    v_xor_b32 v6, s96, v6
    v_xor_b32 v7, s97, v7
    v_or3_b32 v4, v4, v5, v6
    v_or_b32 v4, v4, v7
    v_cmp_ne_u32 vcc, 0, v4
    s_cbranch_vccz L_spd_33
    s_add_u32 s98, s98, 1
    s_cmp_gt_u32 s98, 200000
    s_cbranch_scc1 L_end
    s_sleep 1
    s_branch L_spin_32
L_spd_33:
L_spin_32_x:
    s_mov_b64 exec, s[100:101]
    v_lshlrev_b32 v2, 4, v1
    v_add_u32 v2, 5632, v2
    s_and_b32 exec_lo, s100, 0xffffffff
    s_mov_b32 exec_hi, 0
    s_cbranch_execz L_spin_34_x
    s_mov_b32 s98, 0
L_spin_34:
    buffer_load_dwordx4 v[4:7], v2, s[8:11], 0 offen sc1
    s_waitcnt vmcnt(0)
    v_xor_b32 v4, s96, v4
    v_xor_b32 v5, s97, v5
    v_xor_b32 v6, s96, v6
    v_xor_b32 v7, s97, v7
    v_or3_b32 v4, v4, v5, v6
    v_or_b32 v4, v4, v7
    v_cmp_ne_u32 vcc, 0, v4
    s_cbranch_vccz L_spd_35
    s_add_u32 s98, s98, 1
    s_cmp_gt_u32 s98, 200000
    s_cbranch_scc1 L_end
    s_sleep 1
    s_branch L_spin_34
L_spd_35:
L_spin_34_x:
    s_mov_b64 exec, s[100:101]
    v_lshlrev_b32 v2, 9, v1
    s_lshl_b32 s4, s42, 15
    s_add_u32 s4, s4, 262652
    s_cbranch_execz L_lpd_37
    s_mov_b32 s98, 0
    buffer_load_dword v4, v2, s[8:11], s4 offen sc1
    s_sleep 5
    buffer_load_dword v5, v2, s[8:11], s4 offen sc1
    s_sleep 5
L_lp_36:
    buffer_load_dword v6, v2, s[8:11], s4 offen sc1
    s_waitcnt vmcnt(2)
    v_cmp_eq_u32 vcc, -1, v4
    s_bcnt1_i32_b64 s99, vcc
    s_cmp_le_u32 s99, 24
    s_cbranch_scc1 L_lpd_37
    buffer_load_dword v4, v2, s[8:11], s4 offen sc1
    s_waitcnt vmcnt(2)
    v_cmp_eq_u32 vcc, -1, v5
    s_bcnt1_i32_b64 s99, vcc
    s_cmp_le_u32 s99, 24
    s_cbranch_scc1 L_lpd_37
    buffer_load_dword v5, v2, s[8:11], s4 offen sc1
    s_waitcnt vmcnt(2)
    v_cmp_eq_u32 vcc, -1, v6
    s_bcnt1_i32_b64 s99, vcc
    s_cmp_le_u32 s99, 24
    s_cbranch_scc1 L_lpd_37
    s_add_u32 s98, s98, 1
    s_cmp_gt_u32 s98, 200000
    s_cbranch_scc1 L_end
    s_branch L_lp_36
L_lpd_37:
L_noh2l_31:
    s_cmp_eq_u32 s100, 0
    s_cbranch_scc1 L_bar_38
    s_barrier
L_bar_38:
    s_lshl_b32 s4, s42, 15
    s_lshl_b32 s5, s3, 12
    s_add_u32 s4, s4, s5
    s_add_u32 s4, s4, 262144
    s_cbranch_execz L_spin_39_x
    s_mov_b32 s98, 0
L_spin_39:
    buffer_load_dwordx4 v[148:151], v13, s[8:11], s4 offen offset:0 sc1
    buffer_load_dwordx4 v[152:155], v13, s[8:11], s4 offen offset:1024 sc1
    buffer_load_dwordx4 v[156:159], v13, s[8:11], s4 offen offset:2048 sc1
    buffer_load_dwordx4 v[160:163], v13, s[8:11], s4 offen offset:3072 sc1
    s_waitcnt vmcnt(0)
    v_max3_u32 v2, v148, v149, v150
    v_max3_u32 v2, v2, v151, v152
    v_max3_u32 v2, v2, v153, v154
    v_max3_u32 v2, v2, v155, v156
    v_max3_u32 v2, v2, v157, v158
    v_max3_u32 v2, v2, v159, v160
    v_max3_u32 v2, v2, v161, v162
    v_max_u32 v2, v2, v163
    v_cmp_eq_u32 vcc, -1, v2
    s_cbranch_vccz L_spd_40
    s_add_u32 s98, s98, 1
    s_cmp_gt_u32 s98, 200000
    s_cbranch_scc1 L_end
    s_sleep 1
    s_branch L_spin_39
L_spd_40:
L_spin_39_x:
    s_lshl_b32 s4, s3, 12
    s_and_b32 s5, s3, 3
    s_lshl_b32 s5, s5, 2
    s_add_u32 s6, s5, 0
    v_xor_b32 v2, s6, v1
    v_lshlrev_b32 v2, 4, v2
    v_add_u32 v2, s4, v2
    ds_write_b128 v2, v[148:151] offset:0
    s_add_u32 s6, s5, 1
    v_xor_b32 v2, s6, v1
    v_lshlrev_b32 v2, 4, v2
    v_add_u32 v2, s4, v2
    ds_write_b128 v2, v[152:155] offset:1024
    s_add_u32 s6, s5, 2
    v_xor_b32 v2, s6, v1
    v_lshlrev_b32 v2, 4, v2
    v_add_u32 v2, s4, v2
    ds_write_b128 v2, v[156:159] offset:2048
    s_add_u32 s6, s5, 3
    v_xor_b32 v2, s6, v1
    v_lshlrev_b32 v2, 4, v2
    v_add_u32 v2, s4, v2
    ds_write_b128 v2, v[160:163] offset:3072
    v_and_b32 v2, 3, v15
    v_xor_b32 v2, v2, v14
    v_and_b32 v3, 12, v15
    v_or_b32 v2, v2, v3
    v_xor_b32 v3, 0, v2
    v_lshlrev_b32 v3, 4, v3
    v_lshl_add_u32 v8, v15, 10, v3
    v_xor_b32 v3, 4, v2
    v_lshlrev_b32 v3, 4, v3
    v_lshl_add_u32 v9, v15, 10, v3
    v_xor_b32 v3, 8, v2
    v_lshlrev_b32 v3, 4, v3
    v_lshl_add_u32 v10, v15, 10, v3
    v_xor_b32 v3, 12, v2
    v_lshlrev_b32 v3, 4, v3
    v_lshl_add_u32 v11, v15, 10, v3
    v_lshlrev_b32 v4, 5, v15
    v_add_u32 v4, 141824, v4
    s_lshl_b32 s4, s3, 2
    v_add_u32 v3, s4, v4
    s_waitcnt lgkmcnt(0)
    s_cmp_eq_u32 s100, 0
    s_cbranch_scc1 L_bar_41
    s_barrier
L_bar_41:
    ds_read_b128 v[148:151], v8 offset:0
    ds_read_b128 v[152:155], v9 offset:0
    ds_read_b128 v[156:159], v10 offset:0
    ds_read_b128 v[160:163], v11 offset:0
    ds_read_b128 v[164:167], v8 offset:256
    ds_read_b128 v[168:171], v9 offset:256
    ds_read_b128 v[172:175], v10 offset:256
    ds_read_b128 v[176:179], v11 offset:256
    ds_read_b128 v[180:183], v8 offset:512
    ds_read_b128 v[184:187], v9 offset:512
    ds_read_b128 v[188:191], v10 offset:512
    ds_read_b128 v[192:195], v11 offset:512
    ds_read_b128 v[196:199], v8 offset:768
    ds_read_b128 v[200:203], v9 offset:768
    ds_read_b128 v[204:207], v10 offset:768
    ds_read_b128 v[208:211], v11 offset:768
    s_waitcnt lgkmcnt(15)
    v_mfma_f32_16x16x32_bf16 v[212:215], v[20:23], v[148:151], 0
    ds_read_b128 v[148:151], v8 offset:16384
    s_waitcnt lgkmcnt(15)
    v_mfma_f32_16x16x32_bf16 v[212:215], v[24:27], v[152:155], v[212:215]
    ds_read_b128 v[152:155], v9 offset:16384
    s_waitcnt lgkmcnt(15)
    v_mfma_f32_16x16x32_bf16 v[212:215], v[28:31], v[156:159], v[212:215]
    ds_read_b128 v[156:159], v10 offset:16384
    s_waitcnt lgkmcnt(15)
    v_mfma_f32_16x16x32_bf16 v[212:215], v[32:35], v[160:163], v[212:215]
    ds_read_b128 v[160:163], v11 offset:16384
    s_waitcnt lgkmcnt(15)
    v_mfma_f32_16x16x32_bf16 v[212:215], v[36:39], v[164:167], v[212:215]
    ds_read_b128 v[164:167], v8 offset:16640
    s_waitcnt lgkmcnt(15)
    v_mfma_f32_16x16x32_bf16 v[212:215], v[40:43], v[168:171], v[212:215]
    ds_read_b128 v[168:171], v9 offset:16640
    s_waitcnt lgkmcnt(15)
    v_mfma_f32_16x16x32_bf16 v[212:215], v[44:47], v[172:175], v[212:215]
    ds_read_b128 v[172:175], v10 offset:16640
    s_waitcnt lgkmcnt(15)
    v_mfma_f32_16x16x32_bf16 v[212:215], v[48:51], v[176:179], v[212:215]
    ds_read_b128 v[176:179], v11 offset:16640
    s_waitcnt lgkmcnt(15)
    v_mfma_f32_16x16x32_bf16 v[212:215], v[52:55], v[180:183], v[212:215]
    ds_read_b128 v[180:183], v8 offset:16896
    s_waitcnt lgkmcnt(15)
    v_mfma_f32_16x16x32_bf16 v[212:215], v[56:59], v[184:187], v[212:215]
    ds_read_b128 v[184:187], v9 offset:16896
    s_waitcnt lgkmcnt(15)
    v_mfma_f32_16x16x32_bf16 v[212:215], v[60:63], v[188:191], v[212:215]
    ds_read_b128 v[188:191], v10 offset:16896
    s_waitcnt lgkmcnt(15)
    v_mfma_f32_16x16x32_bf16 v[212:215], v[64:67], v[192:195], v[212:215]
    ds_read_b128 v[192:195], v11 offset:16896
    s_waitcnt lgkmcnt(15)
    v_mfma_f32_16x16x32_bf16 v[212:215], v[68:71], v[196:199], v[212:215]
    ds_read_b128 v[196:199], v8 offset:17152
    s_waitcnt lgkmcnt(15)
    v_mfma_f32_16x16x32_bf16 v[212:215], v[72:75], v[200:203], v[212:215]
    ds_read_b128 v[200:203], v9 offset:17152
    s_waitcnt lgkmcnt(15)
    v_mfma_f32_16x16x32_bf16 v[212:215], v[76:79], v[204:207], v[212:215]
    ds_read_b128 v[204:207], v10 offset:17152
    s_waitcnt lgkmcnt(15)
    v_mfma_f32_16x16x32_bf16 v[212:215], v[80:83], v[208:211], v[212:215]
    ds_read_b128 v[208:211], v11 offset:17152
    s_waitcnt lgkmcnt(15)
    v_mfma_f32_16x16x32_bf16 v[216:219], v[20:23], v[148:151], 0
    s_waitcnt lgkmcnt(14)
    v_mfma_f32_16x16x32_bf16 v[216:219], v[24:27], v[152:155], v[216:219]
    s_waitcnt lgkmcnt(13)
    v_mfma_f32_16x16x32_bf16 v[216:219], v[28:31], v[156:159], v[216:219]
    s_waitcnt lgkmcnt(12)
    v_mfma_f32_16x16x32_bf16 v[216:219], v[32:35], v[160:163], v[216:219]
    s_waitcnt lgkmcnt(11)
    v_mfma_f32_16x16x32_bf16 v[216:219], v[36:39], v[164:167], v[216:219]
    s_waitcnt lgkmcnt(10)
    v_mfma_f32_16x16x32_bf16 v[216:219], v[40:43], v[168:171], v[216:219]
    s_waitcnt lgkmcnt(9)
    v_mfma_f32_16x16x32_bf16 v[216:219], v[44:47], v[172:175], v[216:219]
    s_waitcnt lgkmcnt(8)
    v_mfma_f32_16x16x32_bf16 v[216:219], v[48:51], v[176:179], v[216:219]
    s_waitcnt lgkmcnt(7)
    v_mfma_f32_16x16x32_bf16 v[216:219], v[52:55], v[180:183], v[216:219]
    s_waitcnt lgkmcnt(6)
    v_mfma_f32_16x16x32_bf16 v[216:219], v[56:59], v[184:187], v[216:219]
    s_waitcnt lgkmcnt(5)
    v_mfma_f32_16x16x32_bf16 v[216:219], v[60:63], v[188:191], v[216:219]
    s_waitcnt lgkmcnt(4)
    v_mfma_f32_16x16x32_bf16 v[216:219], v[64:67], v[192:195], v[216:219]
    s_waitcnt lgkmcnt(3)
    v_mfma_f32_16x16x32_bf16 v[216:219], v[68:71], v[196:199], v[216:219]
    s_waitcnt lgkmcnt(2)
    v_mfma_f32_16x16x32_bf16 v[216:219], v[72:75], v[200:203], v[216:219]
    s_waitcnt lgkmcnt(1)
    v_mfma_f32_16x16x32_bf16 v[216:219], v[76:79], v[204:207], v[216:219]
    s_waitcnt lgkmcnt(0)
    v_mfma_f32_16x16x32_bf16 v[216:219], v[80:83], v[208:211], v[216:219]
    v_max_f32 v220, v212, v213
    v_max3_f32 v220, v220, v214, v215
    v_mov_b32 v222, v220
    s_nop 1
    v_permlane16_swap_b32 v220, v222
    s_nop 0
    v_max_f32 v220, v220, v222
    v_mov_b32 v222, v220
    s_nop 1
    v_permlane32_swap_b32 v220, v222
    s_nop 0
    v_max_f32 v220, v220, v222
    v_max_f32 v221, v216, v217
    v_max3_f32 v221, v221, v218, v219
    v_mov_b32 v222, v221
    s_nop 1
    v_permlane16_swap_b32 v221, v222
    s_nop 0
    v_max_f32 v221, v221, v222
    v_mov_b32 v222, v221
    s_nop 1
    v_permlane32_swap_b32 v221, v222
    s_nop 0
    v_max_f32 v221, v221, v222
    ds_write_b32 v3, v220
    ds_write_b32 v3, v221 offset:512
    v_mul_u32_u24 v5, 272, v15
    v_add_u32 v5, 133120, v5
    v_lshl_add_u32 v3, v14, 3, v5
    s_lshl_b32 s4, s3, 5
    v_add_u32 v3, s4, v3
    v_lshl_add_u32 v5, v14, 4, v5
    s_waitcnt lgkmcnt(0)
    s_cmp_eq_u32 s100, 0
    s_cbranch_scc1 L_bar_42
    s_barrier
L_bar_42:
    ds_read_b128 v[148:151], v4 offset:0
    ds_read_b128 v[152:155], v4 offset:16
    ds_read_b128 v[156:159], v4 offset:512
    ds_read_b128 v[160:163], v4 offset:528
    s_waitcnt lgkmcnt(0)
    v_max3_f32 v220, v148, v149, v150
    v_max3_f32 v220, v220, v151, v152
    v_max3_f32 v220, v220, v153, v154
    v_max_f32 v220, v220, v155
    v_max3_f32 v221, v156, v157, v158
    v_max3_f32 v221, v221, v159, v160
    v_max3_f32 v221, v221, v161, v162
    v_max_f32 v221, v221, v163
    v_sub_f32 v212, v212, v220
    v_sub_f32 v213, v213, v220
    v_sub_f32 v214, v214, v220
    v_sub_f32 v215, v215, v220
    v_sub_f32 v216, v216, v221
    v_sub_f32 v217, v217, v221
    v_sub_f32 v218, v218, v221
    v_sub_f32 v219, v219, v221
    v_exp_f32 v212, v212
    v_exp_f32 v213, v213
    v_exp_f32 v214, v214
    v_exp_f32 v215, v215
    v_exp_f32 v216, v216
    v_exp_f32 v217, v217
    v_exp_f32 v218, v218
    v_exp_f32 v219, v219
    s_nop 0
    v_cvt_pk_bf16_f32 v224, v212, v213
    v_cvt_pk_bf16_f32 v225, v214, v215
    v_cvt_pk_bf16_f32 v226, v216, v217
    v_cvt_pk_bf16_f32 v227, v218, v219
    ds_write_b64 v3, v[224:225]
    ds_write_b64 v3, v[226:227] offset:4352
    v_lshlrev_b32 v2, 15, v15
    v_lshl_add_u32 v2, v14, 4, v2
    s_lshl_b32 s4, s42, 20
    s_lshl_b32 s5, s43, 10
    s_add_u32 s4, s4, s5
    s_lshl_b32 s5, s3, 7
    s_add_u32 s4, s4, s5
    s_add_u32 s4, s4, 1048576
    s_add_u32 s5, s4, 0x80000
    s_waitcnt lgkmcnt(0)
    s_cmp_eq_u32 s100, 0
    s_cbranch_scc1 L_bar_43
    s_barrier
L_bar_43:
    ds_read_b128 v[148:151], v5 offset:0
    ds_read_b128 v[152:155], v5 offset:64
    ds_read_b128 v[156:159], v5 offset:128
    ds_read_b128 v[160:163], v5 offset:192
    ds_read_b128 v[164:167], v5 offset:4352
    ds_read_b128 v[168:171], v5 offset:4416
    ds_read_b128 v[172:175], v5 offset:4480
    ds_read_b128 v[176:179], v5 offset:4544
    s_cmp_gt_u32 s3, 1
    s_cbranch_scc1 L_p3_nol
    s_waitcnt lgkmcnt(0)
    s_cmp_gt_u32 s3, 1
    s_cbranch_scc1 L_p3_nol
    v_mfma_f32_16x16x32_bf16 v[36:39], v[16:19], v[148:151], 0
    v_mfma_f32_16x16x32_bf16 v[36:39], v[16:19], v[152:155], v[36:39]
    v_mfma_f32_16x16x32_bf16 v[36:39], v[16:19], v[156:159], v[36:39]
    v_mfma_f32_16x16x32_bf16 v[36:39], v[16:19], v[160:163], v[36:39]
    v_mfma_f32_16x16x32_bf16 v[40:43], v[16:19], v[164:167], 0
    v_mfma_f32_16x16x32_bf16 v[40:43], v[16:19], v[168:171], v[40:43]
    v_mfma_f32_16x16x32_bf16 v[40:43], v[16:19], v[172:175], v[40:43]
    v_mfma_f32_16x16x32_bf16 v[40:43], v[16:19], v[176:179], v[40:43]
    v_lshlrev_b32 v3, 8, v1
    s_lshl_b32 s6, s42, 13
    s_lshl_b32 s7, s3, 12
    s_add_u32 s6, s6, s7
    s_lshl_b32 s7, s43, 3
    s_add_u32 s6, s6, s7
    s_add_u32 s6, s6, 327680
    s_cmp_eq_u32 s3, 0
    s_cselect_b64 vcc, -1, 0
    s_nop 1
    v_cndmask_b32 v44, v221, v220, vcc
    v_cndmask_b32 v45, v40, v36, vcc
    v_min_u32 v44, 0xfffffffe, v44
    v_min_u32 v45, 0xfffffffe, v45
    s_and_b32 exec_lo, s100, 0xffff
    s_mov_b32 exec_hi, 0
    buffer_store_dwordx2 v[44:45], v3, s[8:11], s6 offen sc1
    s_mov_b64 exec, s[100:101]
L_p3_nol:
    s_waitcnt lgkmcnt(7)
    v_mfma_f32_16x16x32_bf16 v[180:183], v[84:87], v[148:151], 0
    v_mfma_f32_16x16x32_bf16 v[184:187], v[100:103], v[148:151], 0
    v_mfma_f32_16x16x32_bf16 v[188:191], v[116:119], v[148:151], 0
    v_mfma_f32_16x16x32_bf16 v[192:195], v[132:135], v[148:151], 0
    s_waitcnt lgkmcnt(6)
    v_mfma_f32_16x16x32_bf16 v[180:183], v[88:91], v[152:155], v[180:183]
    v_mfma_f32_16x16x32_bf16 v[184:187], v[104:107], v[152:155], v[184:187]
    v_mfma_f32_16x16x32_bf16 v[188:191], v[120:123], v[152:155], v[188:191]
    v_mfma_f32_16x16x32_bf16 v[192:195], v[136:139], v[152:155], v[192:195]
    s_waitcnt lgkmcnt(5)
    v_mfma_f32_16x16x32_bf16 v[180:183], v[92:95], v[156:159], v[180:183]
    v_mfma_f32_16x16x32_bf16 v[184:187], v[108:111], v[156:159], v[184:187]
    v_mfma_f32_16x16x32_bf16 v[188:191], v[124:127], v[156:159], v[188:191]
    v_mfma_f32_16x16x32_bf16 v[192:195], v[140:143], v[156:159], v[192:195]
    s_waitcnt lgkmcnt(4)
    v_mfma_f32_16x16x32_bf16 v[180:183], v[96:99], v[160:163], v[180:183]
    v_mfma_f32_16x16x32_bf16 v[184:187], v[112:115], v[160:163], v[184:187]
    v_mfma_f32_16x16x32_bf16 v[188:191], v[128:131], v[160:163], v[188:191]
    v_mfma_f32_16x16x32_bf16 v[192:195], v[144:147], v[160:163], v[192:195]
    s_waitcnt lgkmcnt(3)
    v_mfma_f32_16x16x32_bf16 v[196:199], v[84:87], v[164:167], 0
    v_mfma_f32_16x16x32_bf16 v[200:203], v[100:103], v[164:167], 0
    v_mfma_f32_16x16x32_bf16 v[204:207], v[116:119], v[164:167], 0
    v_mfma_f32_16x16x32_bf16 v[208:211], v[132:135], v[164:167], 0
    s_waitcnt lgkmcnt(2)
    v_mfma_f32_16x16x32_bf16 v[196:199], v[88:91], v[168:171], v[196:199]
    v_mfma_f32_16x16x32_bf16 v[200:203], v[104:107], v[168:171], v[200:203]
    v_mfma_f32_16x16x32_bf16 v[204:207], v[120:123], v[168:171], v[204:207]
    v_mfma_f32_16x16x32_bf16 v[208:211], v[136:139], v[168:171], v[208:211]
    s_waitcnt lgkmcnt(1)
    v_mfma_f32_16x16x32_bf16 v[196:199], v[92:95], v[172:175], v[196:199]
    v_mfma_f32_16x16x32_bf16 v[200:203], v[108:111], v[172:175], v[200:203]
    v_mfma_f32_16x16x32_bf16 v[204:207], v[124:127], v[172:175], v[204:207]
    v_mfma_f32_16x16x32_bf16 v[208:211], v[140:143], v[172:175], v[208:211]
    s_waitcnt lgkmcnt(0)
    v_mfma_f32_16x16x32_bf16 v[196:199], v[96:99], v[176:179], v[196:199]
    v_mfma_f32_16x16x32_bf16 v[200:203], v[112:115], v[176:179], v[200:203]
    v_mfma_f32_16x16x32_bf16 v[204:207], v[128:131], v[176:179], v[204:207]
    v_mfma_f32_16x16x32_bf16 v[208:211], v[144:147], v[176:179], v[208:211]
    s_nop 0
    v_cvt_pk_bf16_f32 v20, v180, v181
    v_cvt_pk_bf16_f32 v21, v182, v183
    v_cvt_pk_bf16_f32 v22, v184, v185
    v_cvt_pk_bf16_f32 v23, v186, v187
    v_cvt_pk_bf16_f32 v24, v188, v189
    v_cvt_pk_bf16_f32 v25, v190, v191
    v_cvt_pk_bf16_f32 v26, v192, v193
    v_cvt_pk_bf16_f32 v27, v194, v195
    v_min_u32 v20, 0xfffffffe, v20
    v_min_u32 v21, 0xfffffffe, v21
    v_min_u32 v22, 0xfffffffe, v22
    v_min_u32 v23, 0xfffffffe, v23
    v_min_u32 v24, 0xfffffffe, v24
    v_min_u32 v25, 0xfffffffe, v25
    v_min_u32 v26, 0xfffffffe, v26
    v_min_u32 v27, 0xfffffffe, v27
    buffer_store_dwordx4 v[20:23], v2, s[8:11], s4 offen sc1
    buffer_store_dwordx4 v[24:27], v2, s[8:11], s4 offen offset:64 sc1
    v_cvt_pk_bf16_f32 v28, v196, v197
    v_cvt_pk_bf16_f32 v29, v198, v199
    v_cvt_pk_bf16_f32 v30, v200, v201
    v_cvt_pk_bf16_f32 v31, v202, v203
    v_cvt_pk_bf16_f32 v32, v204, v205
    v_cvt_pk_bf16_f32 v33, v206, v207
    v_cvt_pk_bf16_f32 v34, v208, v209
    v_cvt_pk_bf16_f32 v35, v210, v211
    v_min_u32 v28, 0xfffffffe, v28
    v_min_u32 v29, 0xfffffffe, v29
    v_min_u32 v30, 0xfffffffe, v30
    v_min_u32 v31, 0xfffffffe, v31
    v_min_u32 v32, 0xfffffffe, v32
    v_min_u32 v33, 0xfffffffe, v33
    v_min_u32 v34, 0xfffffffe, v34
    v_min_u32 v35, 0xfffffffe, v35
    buffer_store_dwordx4 v[28:31], v2, s[8:11], s5 offen sc1
    buffer_store_dwordx4 v[32:35], v2, s[8:11], s5 offen offset:64 sc1
L_p3_done:
    s_cmp_lg_u32 s100, 0
    s_cbranch_scc1 L_end
    s_mov_b64 s[100:101], -1
    s_mov_b64 exec, -1
    s_branch L_p3_real
L_de:
    s_mov_b32 s12, s84
    s_and_b32 s13, s85, 0xffff
    s_mov_b32 s14, 2560
    s_mov_b32 s15, 0x00020000
    s_mov_b32 s16, s86
    s_and_b32 s17, s87, 0xffff
    s_mov_b32 s18, 4915200
    s_mov_b32 s19, 0x00020000
    s_sub_u32 s40, s2, 128
    v_lshrrev_b32 v14, 4, v1
    v_and_b32 v15, 15, v1
    v_lshlrev_b32 v13, 4, v1
    s_and_b32 s4, s40, 63
    s_and_b32 s5, s4, 3
    s_lshr_b32 s6, s4, 3
    s_lshl_b32 s6, s6, 2
    s_add_u32 s42, s6, s5
    s_bfe_u32 s43, s4, 0x10002
    s_mov_b32 s47, 0
    s_cmp_lt_u32 s40, 64
    s_cbranch_scc1 L_dec_done
    s_cmp_ge_u32 s42, 27
    s_cselect_b32 s47, 1, 0
L_dec_done:
    s_cmp_lg_u32 s3, 7
    s_cbranch_scc1 L_noclr_44
    v_mov_b32 v4, -1
    v_mov_b32 v5, -1
    v_mov_b32 v6, -1
    v_mov_b32 v7, -1
    v_lshrrev_b32 v2, 5, v1
    v_lshlrev_b32 v2, 13, v2
    v_bfe_u32 v3, v1, 4, 1
    v_mul_u32_u24 v3, 15360, v3
    v_add_u32 v2, v2, v3
    v_lshl_add_u32 v2, v15, 4, v2
    s_and_b32 s4, s40, 3
    s_mul_i32 s4, s4, 30720
    s_lshr_b32 s5, s40, 2
    s_lshl_b32 s5, s5, 8
    s_add_u32 s4, s4, s5
    s_add_u32 s4, s4, 8192
    s_cmp_lt_u32 s40, 112
    s_cselect_b32 exec_hi, -1, 0
    buffer_store_dwordx4 v[4:7], v2, s[8:11], s4 offen sc1
    s_mov_b64 exec, s[100:101]
    s_cmp_ge_u32 s40, 64
    s_cbranch_scc1 L_clr_e
    s_lshl_b32 s4, s43, 5
    s_add_u32 s4, s4, s42
    s_mul_i32 s4, s4, 1280
    s_add_u32 s4, s4, 360448
    buffer_store_dwordx4 v[4:7], v13, s[8:11], s4 offen sc1
    s_and_b32 exec_lo, s100, 0xffff
    s_mov_b32 exec_hi, 0
    buffer_store_dwordx4 v[4:7], v13, s[8:11], s4 offen offset:1024 sc1
    s_mov_b64 exec, s[100:101]
    s_branch L_clr_done
L_clr_e:
    s_cmp_lg_u32 s47, 0
    s_cbranch_scc1 L_clr_done
    s_mul_i32 s4, s43, 27
    s_add_u32 s4, s4, s42
    s_mul_i32 s4, s4, 2560
    s_add_u32 s4, s4, 442368
    buffer_store_dwordx4 v[4:7], v13, s[8:11], s4 offen sc1
    buffer_store_dwordx4 v[4:7], v13, s[8:11], s4 offen offset:1024 sc1
    s_and_b32 exec_lo, s100, 0xffffffff
    s_mov_b32 exec_hi, 0
    buffer_store_dwordx4 v[4:7], v13, s[8:11], s4 offen offset:2048 sc1
    s_mov_b64 exec, s[100:101]
L_clr_done:
    s_waitcnt vmcnt(0) lgkmcnt(0)
    s_add_u32 s96, s94, 0x7f4a7c15
    s_addc_u32 s97, s95, 0x9e3779b9
    v_mov_b32 v8, s96
    v_mov_b32 v9, s97
    s_lshl_b32 s4, s2, 3
    s_add_u32 s4, s4, 2048
    v_mov_b32 v10, 0
    s_and_b32 exec_lo, s100, 0x1
    s_mov_b32 exec_hi, 0
    buffer_store_dwordx2 v[8:9], v10, s[8:11], s4 offen sc1
    s_mov_b64 exec, s[100:101]
L_noclr_44:
    s_and_b32 s45, s40, 3
    s_lshr_b32 s46, s40, 2
    s_cmp_gt_u32 s3, 3
    s_cbranch_scc1 L_c_hi
    v_lshrrev_b32 v2, 3, v1
    v_and_b32 v3, 7, v1
    v_xor_b32 v3, v3, v2
    v_mul_u32_u24 v2, 7680, v2
    v_lshl_add_u32 v2, v3, 4, v2
    s_mul_i32 s4, s45, 1228800
    s_lshl_b32 s5, s46, 7
    s_add_u32 s4, s4, s5
    s_mul_i32 s6, s3, 307200
    s_add_u32 s4, s4, s6
    s_mul_i32 s5, s3, 5120
    s_mov_b32 m0, s5
    s_nop 0
    buffer_load_dwordx4 v2, s[16:19], s4 offen nt lds
    s_add_u32 s4, s4, 61440
    s_add_u32 s5, s5, 1024
    s_mov_b32 m0, s5
    s_nop 0
    buffer_load_dwordx4 v2, s[16:19], s4 offen nt lds
    s_add_u32 s4, s4, 61440
    s_add_u32 s5, s5, 1024
    s_mov_b32 m0, s5
    s_nop 0
    buffer_load_dwordx4 v2, s[16:19], s4 offen nt lds
    s_add_u32 s4, s4, 61440
    s_add_u32 s5, s5, 1024
    s_mov_b32 m0, s5
    s_nop 0
    buffer_load_dwordx4 v2, s[16:19], s4 offen nt lds
    s_add_u32 s4, s4, 61440
    s_add_u32 s5, s5, 1024
    s_mov_b32 m0, s5
    s_nop 0
    buffer_load_dwordx4 v2, s[16:19], s4 offen nt lds
    v_lshrrev_b32 v2, 2, v15
    v_lshl_add_u32 v2, v14, 2, v2
    v_and_b32 v3, 7, v2
    v_bfe_u32 v4, v15, 1, 1
    v_xor_b32 v3, v3, v4
    v_lshlrev_b32 v2, 7, v2
    v_and_b32 v4, 1, v15
    v_lshl_add_u32 v2, v4, 3, v2
    s_lshl_b32 s6, s3, 1
    v_xor_b32 v4, s6, v3
    v_lshl_add_u32 v8, v4, 4, v2
    v_mul_u32_u24 v9, 15360, v15
    v_lshl_add_u32 v9, v14, 4, v9
    s_mul_i32 s4, s45, 30720
    s_lshl_b32 s5, s46, 8
    s_add_u32 s4, s4, s5
    s_lshl_b32 s5, s3, 6
    s_add_u32 s4, s4, s5
    s_add_u32 s44, s4, 8192
    s_waitcnt vmcnt(0)
    s_branch L_c_bar
L_c_hi:
    s_cmp_gt_u32 s3, 5
    s_cbranch_scc1 L_c_bar
    s_sub_u32 s6, s3, 4
    s_mul_i32 s4, s6, 1280
    s_mul_i32 s5, s45, 320
    s_add_u32 s4, s4, s5
    v_lshlrev_b32 v2, 3, v1
    buffer_load_dwordx2 v[4:5], v2, s[12:15], s4 offen
    v_lshrrev_b32 v8, 3, v1
    v_and_b32 v9, 3, v1
    v_bfe_u32 v10, v1, 2, 1
    v_lshlrev_b32 v6, 6, v8
    v_lshl_add_u32 v6, v9, 4, v6
    v_lshl_add_u32 v6, v10, 3, v6
    s_mul_i32 s4, s6, 320
    s_add_u32 s4, s4, 40960
    v_add_u32 v6, s4, v6
    v_mov_b32 v12, 44032
    v_mov_b32 v7, 0
    ds_write_b32 v12, v7
    s_waitcnt vmcnt(0)
    v_lshlrev_b32 v8, 16, v4
    v_and_b32 v9, 0xffff0000, v4
    v_lshlrev_b32 v10, 16, v5
    v_and_b32 v11, 0xffff0000, v5
    v_mul_f32 v16, 0xbfb8aa3b, v8
    v_mul_f32 v17, 0xbfb8aa3b, v9
    v_mul_f32 v18, 0xbfb8aa3b, v10
    v_mul_f32 v19, 0xbfb8aa3b, v11
    v_exp_f32 v16, v16
    v_exp_f32 v17, v17
    v_exp_f32 v18, v18
    v_exp_f32 v19, v19
    v_add_f32 v16, 1.0, v16
    v_add_f32 v17, 1.0, v17
    v_add_f32 v18, 1.0, v18
    v_add_f32 v19, 1.0, v19
    v_rcp_f32 v16, v16
    v_rcp_f32 v17, v17
    v_rcp_f32 v18, v18
    v_rcp_f32 v19, v19
    v_mul_f32 v16, v8, v16
    v_mul_f32 v17, v9, v17
    v_mul_f32 v18, v10, v18
    v_mul_f32 v19, v11, v19
    v_cvt_pk_bf16_f32 v4, v16, v17
    v_cvt_pk_bf16_f32 v5, v18, v19
    s_and_b32 exec_lo, s100, 0xffffffff
    s_and_b32 exec_hi, s100, 0xff
    ds_write_b64 v6, v[4:5]
    s_mov_b64 exec, s[100:101]
    s_waitcnt lgkmcnt(0)
L_c_bar:
    s_cmp_eq_u32 s100, 0
    s_cbranch_scc1 L_bar_45
    s_barrier
L_bar_45:
    s_cmp_gt_u32 s3, 3
    s_cbranch_scc1 L_c_hi2
    v_and_b32 v5, 1, v15
    v_mul_u32_u24 v5, 320, v5
    v_lshl_add_u32 v5, v14, 4, v5
    ds_read_b128 v[20:23], v5 offset:40960
    ds_read_b128 v[24:27], v5 offset:41024
    ds_read_b128 v[28:31], v5 offset:41088
    ds_read_b128 v[32:35], v5 offset:41152
    ds_read_b128 v[36:39], v5 offset:41216
    ds_read_b64_tr_b16 v[40:41], v8 offset:0
    ds_read_b64_tr_b16 v[42:43], v8 offset:2048
    ds_read_b64_tr_b16 v[44:45], v8 offset:4096
    ds_read_b64_tr_b16 v[46:47], v8 offset:6144
    ds_read_b64_tr_b16 v[48:49], v8 offset:8192
    ds_read_b64_tr_b16 v[50:51], v8 offset:10240
    ds_read_b64_tr_b16 v[52:53], v8 offset:12288
    ds_read_b64_tr_b16 v[54:55], v8 offset:14336
    ds_read_b64_tr_b16 v[56:57], v8 offset:16384
    ds_read_b64_tr_b16 v[58:59], v8 offset:18432
    s_waitcnt lgkmcnt(8)
    v_mfma_f32_16x16x32_bf16 v[60:63], v[40:43], v[20:23], 0
    s_waitcnt lgkmcnt(6)
    v_mfma_f32_16x16x32_bf16 v[60:63], v[44:47], v[24:27], v[60:63]
    s_waitcnt lgkmcnt(4)
    v_mfma_f32_16x16x32_bf16 v[60:63], v[48:51], v[28:31], v[60:63]
    s_waitcnt lgkmcnt(2)
    v_mfma_f32_16x16x32_bf16 v[60:63], v[52:55], v[32:35], v[60:63]
    s_waitcnt lgkmcnt(0)
    v_mfma_f32_16x16x32_bf16 v[60:63], v[56:59], v[36:39], v[60:63]
    s_nop 8
    v_min_u32 v60, 0xfffffffe, v60
    v_min_u32 v61, 0xfffffffe, v61
    v_min_u32 v62, 0xfffffffe, v62
    v_min_u32 v63, 0xfffffffe, v63
    s_and_b32 exec_lo, s100, 0x30003
    s_and_b32 exec_hi, s100, 0x30003
    buffer_store_dwordx4 v[60:63], v9, s[8:11], s44 offen sc1
    s_mov_b64 exec, s[100:101]
    s_waitcnt lgkmcnt(0)
    s_add_u32 s96, s94, 0x7f4a7c15
    s_addc_u32 s97, s95, 0x9e3779b9
    s_branch L_c_done
L_c_hi2:
    s_waitcnt lgkmcnt(0)
    s_add_u32 s96, s94, 0x7f4a7c15
    s_addc_u32 s97, s95, 0x9e3779b9
    s_cmp_lg_u32 s3, 6
    s_cbranch_scc1 L_c_n6
    s_cmp_lt_u32 s40, 64
    s_cbranch_scc1 L_c_done
    v_mov_b32 v4, -1
    v_mov_b32 v5, -1
    v_mov_b32 v6, -1
    v_mov_b32 v7, -1
    s_sub_u32 s6, s40, 64
    s_lshl_b32 s7, s6, 15
    s_add_u32 s7, s7, 1048576
    buffer_store_dwordx4 v[4:7], v13, s[8:11], s7 offen offset:0 sc1
    buffer_store_dwordx4 v[4:7], v13, s[8:11], s7 offen offset:1024 sc1
    buffer_store_dwordx4 v[4:7], v13, s[8:11], s7 offen offset:2048 sc1
    buffer_store_dwordx4 v[4:7], v13, s[8:11], s7 offen offset:3072 sc1
    s_add_u32 s7, s7, 4096
    buffer_store_dwordx4 v[4:7], v13, s[8:11], s7 offen offset:0 sc1
    buffer_store_dwordx4 v[4:7], v13, s[8:11], s7 offen offset:1024 sc1
    buffer_store_dwordx4 v[4:7], v13, s[8:11], s7 offen offset:2048 sc1
    buffer_store_dwordx4 v[4:7], v13, s[8:11], s7 offen offset:3072 sc1
    s_add_u32 s7, s7, 4096
    buffer_store_dwordx4 v[4:7], v13, s[8:11], s7 offen offset:0 sc1
    buffer_store_dwordx4 v[4:7], v13, s[8:11], s7 offen offset:1024 sc1
    buffer_store_dwordx4 v[4:7], v13, s[8:11], s7 offen offset:2048 sc1
    buffer_store_dwordx4 v[4:7], v13, s[8:11], s7 offen offset:3072 sc1
    s_add_u32 s7, s7, 4096
    buffer_store_dwordx4 v[4:7], v13, s[8:11], s7 offen offset:0 sc1
    buffer_store_dwordx4 v[4:7], v13, s[8:11], s7 offen offset:1024 sc1
    buffer_store_dwordx4 v[4:7], v13, s[8:11], s7 offen offset:2048 sc1
    buffer_store_dwordx4 v[4:7], v13, s[8:11], s7 offen offset:3072 sc1
    s_add_u32 s7, s7, 4096
    buffer_store_dwordx4 v[4:7], v13, s[8:11], s7 offen offset:0 sc1
    buffer_store_dwordx4 v[4:7], v13, s[8:11], s7 offen offset:1024 sc1
    buffer_store_dwordx4 v[4:7], v13, s[8:11], s7 offen offset:2048 sc1
    buffer_store_dwordx4 v[4:7], v13, s[8:11], s7 offen offset:3072 sc1
    s_add_u32 s7, s7, 4096
    buffer_store_dwordx4 v[4:7], v13, s[8:11], s7 offen offset:0 sc1
    buffer_store_dwordx4 v[4:7], v13, s[8:11], s7 offen offset:1024 sc1
    buffer_store_dwordx4 v[4:7], v13, s[8:11], s7 offen offset:2048 sc1
    buffer_store_dwordx4 v[4:7], v13, s[8:11], s7 offen offset:3072 sc1
    s_add_u32 s7, s7, 4096
    buffer_store_dwordx4 v[4:7], v13, s[8:11], s7 offen offset:0 sc1
    buffer_store_dwordx4 v[4:7], v13, s[8:11], s7 offen offset:1024 sc1
    buffer_store_dwordx4 v[4:7], v13, s[8:11], s7 offen offset:2048 sc1
    buffer_store_dwordx4 v[4:7], v13, s[8:11], s7 offen offset:3072 sc1
    s_add_u32 s7, s7, 4096
    buffer_store_dwordx4 v[4:7], v13, s[8:11], s7 offen offset:0 sc1
    buffer_store_dwordx4 v[4:7], v13, s[8:11], s7 offen offset:1024 sc1
    buffer_store_dwordx4 v[4:7], v13, s[8:11], s7 offen offset:2048 sc1
    buffer_store_dwordx4 v[4:7], v13, s[8:11], s7 offen offset:3072 sc1
    s_lshl_b32 s7, s6, 8
    s_add_u32 s7, s7, 327680
    s_and_b32 exec_lo, s100, 0xffff
    s_mov_b32 exec_hi, 0
    buffer_store_dwordx4 v[4:7], v13, s[8:11], s7 offen sc1
    s_mov_b64 exec, s[100:101]
    s_waitcnt vmcnt(0) lgkmcnt(0)
    s_add_u32 s96, s94, 0x7f4a7c15
    s_addc_u32 s97, s95, 0x9e3779b9
    v_mov_b32 v8, s96
    v_mov_b32 v9, s97
    s_lshl_b32 s4, s2, 3
    s_add_u32 s4, s4, 4096
    v_mov_b32 v10, 0
    s_and_b32 exec_lo, s100, 0x1
    s_mov_b32 exec_hi, 0
    buffer_store_dwordx2 v[8:9], v10, s[8:11], s4 offen sc1
    s_mov_b64 exec, s[100:101]
    s_branch L_c_done
L_c_n6:
    s_cmp_lg_u32 s3, 5
    s_cbranch_scc1 L_c_done
    s_cmp_ge_u32 s40, 112
    s_cbranch_scc1 L_c_done
    s_add_u32 s46, s46, 32
    v_lshrrev_b32 v2, 3, v1
    v_and_b32 v3, 7, v1
    v_xor_b32 v3, v3, v2
    v_mul_u32_u24 v2, 7680, v2
    v_lshl_add_u32 v2, v3, 4, v2
    s_mul_i32 s4, s45, 1228800
    s_lshl_b32 s5, s46, 7
    s_add_u32 s4, s4, s5
    s_mov_b32 s5, 20480
    s_mov_b32 m0, s5
    s_nop 0
    buffer_load_dwordx4 v2, s[16:19], s4 offen nt lds
    s_add_u32 s4, s4, 61440
    s_add_u32 s5, s5, 1024
    s_mov_b32 m0, s5
    s_nop 0
    buffer_load_dwordx4 v2, s[16:19], s4 offen nt lds
    s_add_u32 s4, s4, 61440
    s_add_u32 s5, s5, 1024
    s_mov_b32 m0, s5
    s_nop 0
    buffer_load_dwordx4 v2, s[16:19], s4 offen nt lds
    s_add_u32 s4, s4, 61440
    s_add_u32 s5, s5, 1024
    s_mov_b32 m0, s5
    s_nop 0
    buffer_load_dwordx4 v2, s[16:19], s4 offen nt lds
    s_add_u32 s4, s4, 61440
    s_add_u32 s5, s5, 1024
    s_mov_b32 m0, s5
    s_nop 0
    buffer_load_dwordx4 v2, s[16:19], s4 offen nt lds
    s_add_u32 s4, s4, 61440
    s_add_u32 s5, s5, 1024
    s_mov_b32 m0, s5
    s_nop 0
    buffer_load_dwordx4 v2, s[16:19], s4 offen nt lds
    s_add_u32 s4, s4, 61440
    s_add_u32 s5, s5, 1024
    s_mov_b32 m0, s5
    s_nop 0
    buffer_load_dwordx4 v2, s[16:19], s4 offen nt lds
    s_add_u32 s4, s4, 61440
    s_add_u32 s5, s5, 1024
    s_mov_b32 m0, s5
    s_nop 0
    buffer_load_dwordx4 v2, s[16:19], s4 offen nt lds
    s_add_u32 s4, s4, 61440
    s_add_u32 s5, s5, 1024
    s_mov_b32 m0, s5
    s_nop 0
    buffer_load_dwordx4 v2, s[16:19], s4 offen nt lds
    s_add_u32 s4, s4, 61440
    s_add_u32 s5, s5, 1024
    s_mov_b32 m0, s5
    s_nop 0
    buffer_load_dwordx4 v2, s[16:19], s4 offen nt lds
    s_add_u32 s4, s4, 61440
    s_add_u32 s5, s5, 1024
    s_mov_b32 m0, s5
    s_nop 0
    buffer_load_dwordx4 v2, s[16:19], s4 offen nt lds
    s_add_u32 s4, s4, 61440
    s_add_u32 s5, s5, 1024
    s_mov_b32 m0, s5
    s_nop 0
    buffer_load_dwordx4 v2, s[16:19], s4 offen nt lds
    s_add_u32 s4, s4, 61440
    s_add_u32 s5, s5, 1024
    s_mov_b32 m0, s5
    s_nop 0
    buffer_load_dwordx4 v2, s[16:19], s4 offen nt lds
    s_add_u32 s4, s4, 61440
    s_add_u32 s5, s5, 1024
    s_mov_b32 m0, s5
    s_nop 0
    buffer_load_dwordx4 v2, s[16:19], s4 offen nt lds
    s_add_u32 s4, s4, 61440
    s_add_u32 s5, s5, 1024
    s_mov_b32 m0, s5
    s_nop 0
    buffer_load_dwordx4 v2, s[16:19], s4 offen nt lds
    s_add_u32 s4, s4, 61440
    s_add_u32 s5, s5, 1024
    s_mov_b32 m0, s5
    s_nop 0
    buffer_load_dwordx4 v2, s[16:19], s4 offen nt lds
    s_add_u32 s4, s4, 61440
    s_add_u32 s5, s5, 1024
    s_mov_b32 m0, s5
    s_nop 0
    buffer_load_dwordx4 v2, s[16:19], s4 offen nt lds
    s_add_u32 s4, s4, 61440
    s_add_u32 s5, s5, 1024
    s_mov_b32 m0, s5
    s_nop 0
    buffer_load_dwordx4 v2, s[16:19], s4 offen nt lds
    s_add_u32 s4, s4, 61440
    s_add_u32 s5, s5, 1024
    s_mov_b32 m0, s5
    s_nop 0
    buffer_load_dwordx4 v2, s[16:19], s4 offen nt lds
    s_add_u32 s4, s4, 61440
    s_add_u32 s5, s5, 1024
    s_mov_b32 m0, s5
    s_nop 0
    buffer_load_dwordx4 v2, s[16:19], s4 offen nt lds
    v_and_b32 v5, 1, v15
    v_mul_u32_u24 v5, 320, v5
    v_lshl_add_u32 v5, v14, 4, v5
    ds_read_b128 v[20:23], v5 offset:40960
    ds_read_b128 v[24:27], v5 offset:41024
    ds_read_b128 v[28:31], v5 offset:41088
    ds_read_b128 v[32:35], v5 offset:41152
    ds_read_b128 v[36:39], v5 offset:41216
    v_lshrrev_b32 v2, 2, v15
    v_lshl_add_u32 v2, v14, 2, v2
    v_and_b32 v3, 7, v2
    v_bfe_u32 v4, v15, 1, 1
    v_xor_b32 v3, v3, v4
    v_lshlrev_b32 v2, 7, v2
    v_and_b32 v4, 1, v15
    v_lshl_add_u32 v2, v4, 3, v2
    v_add_u32 v2, 20480, v2
    v_xor_b32 v4, 0, v3
    v_lshl_add_u32 v8, v4, 4, v2
    v_xor_b32 v4, 2, v3
    v_lshl_add_u32 v9, v4, 4, v2
    v_xor_b32 v4, 4, v3
    v_lshl_add_u32 v10, v4, 4, v2
    v_xor_b32 v4, 6, v3
    v_lshl_add_u32 v11, v4, 4, v2
    s_waitcnt vmcnt(0)
    ds_read_b64_tr_b16 v[40:41], v8 offset:0
    ds_read_b64_tr_b16 v[42:43], v8 offset:2048
    ds_read_b64_tr_b16 v[44:45], v8 offset:4096
    ds_read_b64_tr_b16 v[46:47], v8 offset:6144
    ds_read_b64_tr_b16 v[48:49], v8 offset:8192
    ds_read_b64_tr_b16 v[50:51], v8 offset:10240
    ds_read_b64_tr_b16 v[52:53], v8 offset:12288
    ds_read_b64_tr_b16 v[54:55], v8 offset:14336
    ds_read_b64_tr_b16 v[56:57], v8 offset:16384
    ds_read_b64_tr_b16 v[58:59], v8 offset:18432
    ds_read_b64_tr_b16 v[60:61], v9 offset:0
    ds_read_b64_tr_b16 v[62:63], v9 offset:2048
    ds_read_b64_tr_b16 v[64:65], v9 offset:4096
    ds_read_b64_tr_b16 v[66:67], v9 offset:6144
    ds_read_b64_tr_b16 v[68:69], v9 offset:8192
    ds_read_b64_tr_b16 v[70:71], v9 offset:10240
    ds_read_b64_tr_b16 v[72:73], v9 offset:12288
    ds_read_b64_tr_b16 v[74:75], v9 offset:14336
    ds_read_b64_tr_b16 v[76:77], v9 offset:16384
    ds_read_b64_tr_b16 v[78:79], v9 offset:18432
    ds_read_b64_tr_b16 v[80:81], v10 offset:0
    ds_read_b64_tr_b16 v[82:83], v10 offset:2048
    ds_read_b64_tr_b16 v[84:85], v10 offset:4096
    ds_read_b64_tr_b16 v[86:87], v10 offset:6144
    ds_read_b64_tr_b16 v[88:89], v10 offset:8192
    ds_read_b64_tr_b16 v[90:91], v10 offset:10240
    ds_read_b64_tr_b16 v[92:93], v10 offset:12288
    ds_read_b64_tr_b16 v[94:95], v10 offset:14336
    ds_read_b64_tr_b16 v[96:97], v10 offset:16384
    ds_read_b64_tr_b16 v[98:99], v10 offset:18432
    ds_read_b64_tr_b16 v[100:101], v11 offset:0
    ds_read_b64_tr_b16 v[102:103], v11 offset:2048
    ds_read_b64_tr_b16 v[104:105], v11 offset:4096
    ds_read_b64_tr_b16 v[106:107], v11 offset:6144
    ds_read_b64_tr_b16 v[108:109], v11 offset:8192
    ds_read_b64_tr_b16 v[110:111], v11 offset:10240
    ds_read_b64_tr_b16 v[112:113], v11 offset:12288
    ds_read_b64_tr_b16 v[114:115], v11 offset:14336
    ds_read_b64_tr_b16 v[116:117], v11 offset:16384
    ds_read_b64_tr_b16 v[118:119], v11 offset:18432
    s_waitcnt lgkmcnt(0)
    v_mfma_f32_16x16x32_bf16 v[120:123], v[40:43], v[20:23], 0
    v_mfma_f32_16x16x32_bf16 v[124:127], v[60:63], v[20:23], 0
    v_mfma_f32_16x16x32_bf16 v[128:131], v[80:83], v[20:23], 0
    v_mfma_f32_16x16x32_bf16 v[132:135], v[100:103], v[20:23], 0
    v_mfma_f32_16x16x32_bf16 v[120:123], v[44:47], v[24:27], v[120:123]
    v_mfma_f32_16x16x32_bf16 v[124:127], v[64:67], v[24:27], v[124:127]
    v_mfma_f32_16x16x32_bf16 v[128:131], v[84:87], v[24:27], v[128:131]
    v_mfma_f32_16x16x32_bf16 v[132:135], v[104:107], v[24:27], v[132:135]
    v_mfma_f32_16x16x32_bf16 v[120:123], v[48:51], v[28:31], v[120:123]
    v_mfma_f32_16x16x32_bf16 v[124:127], v[68:71], v[28:31], v[124:127]
    v_mfma_f32_16x16x32_bf16 v[128:131], v[88:91], v[28:31], v[128:131]
    v_mfma_f32_16x16x32_bf16 v[132:135], v[108:111], v[28:31], v[132:135]
    v_mfma_f32_16x16x32_bf16 v[120:123], v[52:55], v[32:35], v[120:123]
    v_mfma_f32_16x16x32_bf16 v[124:127], v[72:75], v[32:35], v[124:127]
    v_mfma_f32_16x16x32_bf16 v[128:131], v[92:95], v[32:35], v[128:131]
    v_mfma_f32_16x16x32_bf16 v[132:135], v[112:115], v[32:35], v[132:135]
    v_mfma_f32_16x16x32_bf16 v[120:123], v[56:59], v[36:39], v[120:123]
    v_mfma_f32_16x16x32_bf16 v[124:127], v[76:79], v[36:39], v[124:127]
    v_mfma_f32_16x16x32_bf16 v[128:131], v[96:99], v[36:39], v[128:131]
    v_mfma_f32_16x16x32_bf16 v[132:135], v[116:119], v[36:39], v[132:135]
    s_nop 8
    v_min_u32 v120, 0xfffffffe, v120
    v_min_u32 v121, 0xfffffffe, v121
    v_min_u32 v122, 0xfffffffe, v122
    v_min_u32 v123, 0xfffffffe, v123
    v_min_u32 v124, 0xfffffffe, v124
    v_min_u32 v125, 0xfffffffe, v125
    v_min_u32 v126, 0xfffffffe, v126
    v_min_u32 v127, 0xfffffffe, v127
    v_min_u32 v128, 0xfffffffe, v128
    v_min_u32 v129, 0xfffffffe, v129
    v_min_u32 v130, 0xfffffffe, v130
    v_min_u32 v131, 0xfffffffe, v131
    v_min_u32 v132, 0xfffffffe, v132
    v_min_u32 v133, 0xfffffffe, v133
    v_min_u32 v134, 0xfffffffe, v134
    v_min_u32 v135, 0xfffffffe, v135
    v_mul_u32_u24 v2, 15360, v15
    v_lshl_add_u32 v2, v14, 4, v2
    s_mul_i32 s4, s45, 30720
    s_lshl_b32 s5, s46, 8
    s_add_u32 s4, s4, s5
    s_add_u32 s4, s4, 8192
    s_and_b32 exec_lo, s100, 0x30003
    s_and_b32 exec_hi, s100, 0x30003
    buffer_store_dwordx4 v[120:123], v2, s[8:11], s4 offen offset:0 sc1
    buffer_store_dwordx4 v[124:127], v2, s[8:11], s4 offen offset:64 sc1
    buffer_store_dwordx4 v[128:131], v2, s[8:11], s4 offen offset:128 sc1
    buffer_store_dwordx4 v[132:135], v2, s[8:11], s4 offen offset:192 sc1
    s_mov_b64 exec, s[100:101]
L_c_done:
    s_cmp_ge_u32 s40, 64
    s_cbranch_scc1 L_role_e
    s_mov_b32 s20, s72
    s_and_b32 s21, s73, 0xffff
    s_mov_b32 s22, 4194304
    s_mov_b32 s23, 0x00020000
    s_mov_b32 s24, s74
    s_and_b32 s25, s75, 0xffff
    s_mov_b32 s26, 5242880
    s_mov_b32 s27, 0x00020000
    v_and_b32 v2, 1, v1
    v_cmp_eq_u32 vcc, 1, v2
    v_mov_b32 v3, 0xffff
    v_mov_b32 v2, 0xffff0000
    s_nop 0
    v_cndmask_b32 v3, v3, v2, vcc
    v_and_b32 v2, 8, v1
    v_cmp_eq_u32 vcc, 0, v2
    s_nop 1
    v_cndmask_b32 v3, 0, v3, vcc
    v_bfe_u32 v2, v1, 1, 2
    v_cmp_eq_u32 vcc, 0, v2
    s_nop 1
    v_cndmask_b32 v16, 0, v3, vcc
    v_cmp_eq_u32 vcc, 1, v2
    s_nop 1
    v_cndmask_b32 v17, 0, v3, vcc
    v_cmp_eq_u32 vcc, 2, v2
    s_nop 1
    v_cndmask_b32 v18, 0, v3, vcc
    v_cmp_eq_u32 vcc, 3, v2
    s_nop 1
    v_cndmask_b32 v19, 0, v3, vcc
    v_bfe_u32 v2, v1, 2, 2
    v_cmp_gt_u32 vcc, 1, v2
    s_nop 1
    v_cndmask_b32 v3, 0, -1, vcc
    v_and_b32 v2, 3, v1
    v_cmp_eq_u32 vcc, 0, v2
    s_nop 1
    v_cndmask_b32 v244, 0, v3, vcc
    v_cmp_eq_u32 vcc, 1, v2
    s_nop 1
    v_cndmask_b32 v245, 0, v3, vcc
    v_cmp_eq_u32 vcc, 2, v2
    s_nop 1
    v_cndmask_b32 v246, 0, v3, vcc
    v_cmp_eq_u32 vcc, 3, v2
    s_nop 1
    v_cndmask_b32 v247, 0, v3, vcc
    v_lshlrev_b32 v2, 17, v14
    v_lshl_add_u32 v2, v15, 4, v2
    s_lshl_b32 s4, s3, 19
    s_lshl_b32 s5, s42, 8
    s_add_u32 s4, s4, s5
    buffer_load_dwordx4 v[20:23], v2, s[20:23], s4 offen nt
    s_add_u32 s4, s4, 8192
    buffer_load_dwordx4 v[24:27], v2, s[20:23], s4 offen nt
    s_add_u32 s4, s4, 8192
    buffer_load_dwordx4 v[28:31], v2, s[20:23], s4 offen nt
    s_add_u32 s4, s4, 8192
    buffer_load_dwordx4 v[32:35], v2, s[20:23], s4 offen nt
    s_add_u32 s4, s4, 8192
    buffer_load_dwordx4 v[36:39], v2, s[20:23], s4 offen nt
    s_add_u32 s4, s4, 8192
    buffer_load_dwordx4 v[40:43], v2, s[20:23], s4 offen nt
    s_add_u32 s4, s4, 8192
    buffer_load_dwordx4 v[44:47], v2, s[20:23], s4 offen nt
    s_add_u32 s4, s4, 8192
    buffer_load_dwordx4 v[48:51], v2, s[20:23], s4 offen nt
    s_add_u32 s4, s4, 8192
    buffer_load_dwordx4 v[52:55], v2, s[20:23], s4 offen nt
    s_add_u32 s4, s4, 8192
    buffer_load_dwordx4 v[56:59], v2, s[20:23], s4 offen nt
    s_add_u32 s4, s4, 8192
    buffer_load_dwordx4 v[60:63], v2, s[20:23], s4 offen nt
    s_add_u32 s4, s4, 8192
    buffer_load_dwordx4 v[64:67], v2, s[20:23], s4 offen nt
    s_add_u32 s4, s4, 8192
    buffer_load_dwordx4 v[68:71], v2, s[20:23], s4 offen nt
    s_add_u32 s4, s4, 8192
    buffer_load_dwordx4 v[72:75], v2, s[20:23], s4 offen nt
    s_add_u32 s4, s4, 8192
    buffer_load_dwordx4 v[76:79], v2, s[20:23], s4 offen nt
    s_add_u32 s4, s4, 8192
    buffer_load_dwordx4 v[80:83], v2, s[20:23], s4 offen nt
    s_mul_i32 s5, s42, 163840
    s_cmp_gt_u32 s3, 3
    s_cbranch_scc1 L_d_hi
    v_mul_u32_u24 v3, 40960, v14
    v_lshl_add_u32 v3, v15, 4, v3
    s_lshl_b32 s6, s3, 8
    s_add_u32 s5, s5, s6
    buffer_load_dwordx4 v[84:87], v3, s[24:27], s5 offen offset:0 nt
    buffer_load_dwordx4 v[88:91], v3, s[24:27], s5 offen offset:1280 nt
    buffer_load_dwordx4 v[92:95], v3, s[24:27], s5 offen offset:2560 nt
    s_add_u32 s5, s5, 3840
    buffer_load_dwordx4 v[96:99], v3, s[24:27], s5 offen offset:0 nt
    buffer_load_dwordx4 v[100:103], v3, s[24:27], s5 offen offset:1280 nt
    buffer_load_dwordx4 v[104:107], v3, s[24:27], s5 offen offset:2560 nt
    s_add_u32 s5, s5, 3840
    buffer_load_dwordx4 v[108:111], v3, s[24:27], s5 offen offset:0 nt
    buffer_load_dwordx4 v[112:115], v3, s[24:27], s5 offen offset:1280 nt
    buffer_load_dwordx4 v[116:119], v3, s[24:27], s5 offen offset:2560 nt
    s_add_u32 s5, s5, 3840
    buffer_load_dwordx4 v[120:123], v3, s[24:27], s5 offen offset:0 nt
    buffer_load_dwordx4 v[124:127], v3, s[24:27], s5 offen offset:1280 nt
    buffer_load_dwordx4 v[128:131], v3, s[24:27], s5 offen offset:2560 nt
    s_add_u32 s5, s5, 3840
    buffer_load_dwordx4 v[132:135], v3, s[24:27], s5 offen offset:0 nt
    buffer_load_dwordx4 v[136:139], v3, s[24:27], s5 offen offset:1280 nt
    buffer_load_dwordx4 v[140:143], v3, s[24:27], s5 offen offset:2560 nt
    s_add_u32 s5, s5, 3840
    buffer_load_dwordx4 v[144:147], v3, s[24:27], s5 offen offset:0 nt
    buffer_load_dwordx4 v[148:151], v3, s[24:27], s5 offen offset:1280 nt
    buffer_load_dwordx4 v[152:155], v3, s[24:27], s5 offen offset:2560 nt
    s_add_u32 s5, s5, 3840
    buffer_load_dwordx4 v[156:159], v3, s[24:27], s5 offen offset:0 nt
    buffer_load_dwordx4 v[160:163], v3, s[24:27], s5 offen offset:1280 nt
    buffer_load_dwordx4 v[164:167], v3, s[24:27], s5 offen offset:2560 nt
    s_add_u32 s5, s5, 3840
    buffer_load_dwordx4 v[168:171], v3, s[24:27], s5 offen offset:0 nt
    buffer_load_dwordx4 v[172:175], v3, s[24:27], s5 offen offset:1280 nt
    buffer_load_dwordx4 v[176:179], v3, s[24:27], s5 offen offset:2560 nt
    s_add_u32 s5, s5, 3840
    buffer_load_dwordx4 v[180:183], v3, s[24:27], s5 offen offset:0 nt
    buffer_load_dwordx4 v[184:187], v3, s[24:27], s5 offen offset:1280 nt
    buffer_load_dwordx4 v[188:191], v3, s[24:27], s5 offen offset:2560 nt
    s_add_u32 s5, s5, 3840
    buffer_load_dwordx4 v[192:195], v3, s[24:27], s5 offen offset:0 nt
    buffer_load_dwordx4 v[196:199], v3, s[24:27], s5 offen offset:1280 nt
    buffer_load_dwordx4 v[200:203], v3, s[24:27], s5 offen offset:2560 nt
    s_add_u32 s5, s5, 3840
    buffer_load_dwordx4 v[204:207], v3, s[24:27], s5 offen offset:0 nt
    buffer_load_dwordx4 v[208:211], v3, s[24:27], s5 offen offset:1280 nt
    s_waitcnt vmcnt(0)
    s_mov_b32 s4, 0x05040100
    s_mov_b32 s5, 0x07060302
    v_perm_b32 v6, v24, v20, s4
    v_perm_b32 v24, v24, v20, s5
    v_mov_b32 v20, v6
    v_perm_b32 v7, v25, v21, s4
    v_perm_b32 v25, v25, v21, s5
    v_mov_b32 v21, v7
    v_perm_b32 v6, v26, v22, s4
    v_perm_b32 v26, v26, v22, s5
    v_mov_b32 v22, v6
    v_perm_b32 v7, v27, v23, s4
    v_perm_b32 v27, v27, v23, s5
    v_mov_b32 v23, v7
    v_perm_b32 v6, v32, v28, s4
    v_perm_b32 v32, v32, v28, s5
    v_mov_b32 v28, v6
    v_perm_b32 v7, v33, v29, s4
    v_perm_b32 v33, v33, v29, s5
    v_mov_b32 v29, v7
    v_perm_b32 v6, v34, v30, s4
    v_perm_b32 v34, v34, v30, s5
    v_mov_b32 v30, v6
    v_perm_b32 v7, v35, v31, s4
    v_perm_b32 v35, v35, v31, s5
    v_mov_b32 v31, v7
    v_perm_b32 v6, v40, v36, s4
    v_perm_b32 v40, v40, v36, s5
    v_mov_b32 v36, v6
    v_perm_b32 v7, v41, v37, s4
    v_perm_b32 v41, v41, v37, s5
    v_mov_b32 v37, v7
    v_perm_b32 v6, v42, v38, s4
    v_perm_b32 v42, v42, v38, s5
    v_mov_b32 v38, v6
    v_perm_b32 v7, v43, v39, s4
    v_perm_b32 v43, v43, v39, s5
    v_mov_b32 v39, v7
    v_perm_b32 v6, v48, v44, s4
    v_perm_b32 v48, v48, v44, s5
    v_mov_b32 v44, v6
    v_perm_b32 v7, v49, v45, s4
    v_perm_b32 v49, v49, v45, s5
    v_mov_b32 v45, v7
    v_perm_b32 v6, v50, v46, s4
    v_perm_b32 v50, v50, v46, s5
    v_mov_b32 v46, v6
    v_perm_b32 v7, v51, v47, s4
    v_perm_b32 v51, v51, v47, s5
    v_mov_b32 v47, v7
    v_perm_b32 v6, v56, v52, s4
    v_perm_b32 v56, v56, v52, s5
    v_mov_b32 v52, v6
    v_perm_b32 v7, v57, v53, s4
    v_perm_b32 v57, v57, v53, s5
    v_mov_b32 v53, v7
    v_perm_b32 v6, v58, v54, s4
    v_perm_b32 v58, v58, v54, s5
    v_mov_b32 v54, v6
    v_perm_b32 v7, v59, v55, s4
    v_perm_b32 v59, v59, v55, s5
    v_mov_b32 v55, v7
    v_perm_b32 v6, v64, v60, s4
    v_perm_b32 v64, v64, v60, s5
    v_mov_b32 v60, v6
    v_perm_b32 v7, v65, v61, s4
    v_perm_b32 v65, v65, v61, s5
    v_mov_b32 v61, v7
    v_perm_b32 v6, v66, v62, s4
    v_perm_b32 v66, v66, v62, s5
    v_mov_b32 v62, v6
    v_perm_b32 v7, v67, v63, s4
    v_perm_b32 v67, v67, v63, s5
    v_mov_b32 v63, v7
    v_perm_b32 v6, v72, v68, s4
    v_perm_b32 v72, v72, v68, s5
    v_mov_b32 v68, v6
    v_perm_b32 v7, v73, v69, s4
    v_perm_b32 v73, v73, v69, s5
    v_mov_b32 v69, v7
    v_perm_b32 v6, v74, v70, s4
    v_perm_b32 v74, v74, v70, s5
    v_mov_b32 v70, v6
    v_perm_b32 v7, v75, v71, s4
    v_perm_b32 v75, v75, v71, s5
    v_mov_b32 v71, v7
    v_perm_b32 v6, v80, v76, s4
    v_perm_b32 v80, v80, v76, s5
    v_mov_b32 v76, v6
    v_perm_b32 v7, v81, v77, s4
    v_perm_b32 v81, v81, v77, s5
    v_mov_b32 v77, v7
    v_perm_b32 v6, v82, v78, s4
    v_perm_b32 v82, v82, v78, s5
    v_mov_b32 v78, v6
    v_perm_b32 v7, v83, v79, s4
    v_perm_b32 v83, v83, v79, s5
    v_mov_b32 v79, v7
    v_perm_b32 v6, v88, v84, s4
    v_perm_b32 v88, v88, v84, s5
    v_mov_b32 v84, v6
    v_perm_b32 v7, v89, v85, s4
    v_perm_b32 v89, v89, v85, s5
    v_mov_b32 v85, v7
    v_perm_b32 v6, v90, v86, s4
    v_perm_b32 v90, v90, v86, s5
    v_mov_b32 v86, v6
    v_perm_b32 v7, v91, v87, s4
    v_perm_b32 v91, v91, v87, s5
    v_mov_b32 v87, v7
    v_perm_b32 v6, v96, v92, s4
    v_perm_b32 v96, v96, v92, s5
    v_mov_b32 v92, v6
    v_perm_b32 v7, v97, v93, s4
    v_perm_b32 v97, v97, v93, s5
    v_mov_b32 v93, v7
    v_perm_b32 v6, v98, v94, s4
    v_perm_b32 v98, v98, v94, s5
    v_mov_b32 v94, v6
    v_perm_b32 v7, v99, v95, s4
    v_perm_b32 v99, v99, v95, s5
    v_mov_b32 v95, v7
    v_perm_b32 v6, v104, v100, s4
    v_perm_b32 v104, v104, v100, s5
    v_mov_b32 v100, v6
    v_perm_b32 v7, v105, v101, s4
    v_perm_b32 v105, v105, v101, s5
    v_mov_b32 v101, v7
    v_perm_b32 v6, v106, v102, s4
    v_perm_b32 v106, v106, v102, s5
    v_mov_b32 v102, v6
    v_perm_b32 v7, v107, v103, s4
    v_perm_b32 v107, v107, v103, s5
    v_mov_b32 v103, v7
    v_perm_b32 v6, v112, v108, s4
    v_perm_b32 v112, v112, v108, s5
    v_mov_b32 v108, v6
    v_perm_b32 v7, v113, v109, s4
    v_perm_b32 v113, v113, v109, s5
    v_mov_b32 v109, v7
    v_perm_b32 v6, v114, v110, s4
    v_perm_b32 v114, v114, v110, s5
    v_mov_b32 v110, v6
    v_perm_b32 v7, v115, v111, s4
    v_perm_b32 v115, v115, v111, s5
    v_mov_b32 v111, v7
    v_perm_b32 v6, v120, v116, s4
    v_perm_b32 v120, v120, v116, s5
    v_mov_b32 v116, v6
    v_perm_b32 v7, v121, v117, s4
    v_perm_b32 v121, v121, v117, s5
    v_mov_b32 v117, v7
    v_perm_b32 v6, v122, v118, s4
    v_perm_b32 v122, v122, v118, s5
    v_mov_b32 v118, v6
    v_perm_b32 v7, v123, v119, s4
    v_perm_b32 v123, v123, v119, s5
    v_mov_b32 v119, v7
    v_perm_b32 v6, v128, v124, s4
    v_perm_b32 v128, v128, v124, s5
    v_mov_b32 v124, v6
    v_perm_b32 v7, v129, v125, s4
    v_perm_b32 v129, v129, v125, s5
    v_mov_b32 v125, v7
    v_perm_b32 v6, v130, v126, s4
    v_perm_b32 v130, v130, v126, s5
    v_mov_b32 v126, v6
    v_perm_b32 v7, v131, v127, s4
    v_perm_b32 v131, v131, v127, s5
    v_mov_b32 v127, v7
    v_perm_b32 v6, v136, v132, s4
    v_perm_b32 v136, v136, v132, s5
    v_mov_b32 v132, v6
    v_perm_b32 v7, v137, v133, s4
    v_perm_b32 v137, v137, v133, s5
    v_mov_b32 v133, v7
    v_perm_b32 v6, v138, v134, s4
    v_perm_b32 v138, v138, v134, s5
    v_mov_b32 v134, v6
    v_perm_b32 v7, v139, v135, s4
    v_perm_b32 v139, v139, v135, s5
    v_mov_b32 v135, v7
    v_perm_b32 v6, v144, v140, s4
    v_perm_b32 v144, v144, v140, s5
    v_mov_b32 v140, v6
    v_perm_b32 v7, v145, v141, s4
    v_perm_b32 v145, v145, v141, s5
    v_mov_b32 v141, v7
    v_perm_b32 v6, v146, v142, s4
    v_perm_b32 v146, v146, v142, s5
    v_mov_b32 v142, v6
    v_perm_b32 v7, v147, v143, s4
    v_perm_b32 v147, v147, v143, s5
    v_mov_b32 v143, v7
    v_perm_b32 v6, v152, v148, s4
    v_perm_b32 v152, v152, v148, s5
    v_mov_b32 v148, v6
    v_perm_b32 v7, v153, v149, s4
    v_perm_b32 v153, v153, v149, s5
    v_mov_b32 v149, v7
    v_perm_b32 v6, v154, v150, s4
    v_perm_b32 v154, v154, v150, s5
    v_mov_b32 v150, v6
    v_perm_b32 v7, v155, v151, s4
    v_perm_b32 v155, v155, v151, s5
    v_mov_b32 v151, v7
    v_perm_b32 v6, v160, v156, s4
    v_perm_b32 v160, v160, v156, s5
    v_mov_b32 v156, v6
    v_perm_b32 v7, v161, v157, s4
    v_perm_b32 v161, v161, v157, s5
    v_mov_b32 v157, v7
    v_perm_b32 v6, v162, v158, s4
    v_perm_b32 v162, v162, v158, s5
    v_mov_b32 v158, v6
    v_perm_b32 v7, v163, v159, s4
    v_perm_b32 v163, v163, v159, s5
    v_mov_b32 v159, v7
    v_perm_b32 v6, v168, v164, s4
    v_perm_b32 v168, v168, v164, s5
    v_mov_b32 v164, v6
    v_perm_b32 v7, v169, v165, s4
    v_perm_b32 v169, v169, v165, s5
    v_mov_b32 v165, v7
    v_perm_b32 v6, v170, v166, s4
    v_perm_b32 v170, v170, v166, s5
    v_mov_b32 v166, v6
    v_perm_b32 v7, v171, v167, s4
    v_perm_b32 v171, v171, v167, s5
    v_mov_b32 v167, v7
    v_perm_b32 v6, v176, v172, s4
    v_perm_b32 v176, v176, v172, s5
    v_mov_b32 v172, v6
    v_perm_b32 v7, v177, v173, s4
    v_perm_b32 v177, v177, v173, s5
    v_mov_b32 v173, v7
    v_perm_b32 v6, v178, v174, s4
    v_perm_b32 v178, v178, v174, s5
    v_mov_b32 v174, v6
    v_perm_b32 v7, v179, v175, s4
    v_perm_b32 v179, v179, v175, s5
    v_mov_b32 v175, v7
    v_perm_b32 v6, v184, v180, s4
    v_perm_b32 v184, v184, v180, s5
    v_mov_b32 v180, v6
    v_perm_b32 v7, v185, v181, s4
    v_perm_b32 v185, v185, v181, s5
    v_mov_b32 v181, v7
    v_perm_b32 v6, v186, v182, s4
    v_perm_b32 v186, v186, v182, s5
    v_mov_b32 v182, v6
    v_perm_b32 v7, v187, v183, s4
    v_perm_b32 v187, v187, v183, s5
    v_mov_b32 v183, v7
    v_perm_b32 v6, v192, v188, s4
    v_perm_b32 v192, v192, v188, s5
    v_mov_b32 v188, v6
    v_perm_b32 v7, v193, v189, s4
    v_perm_b32 v193, v193, v189, s5
    v_mov_b32 v189, v7
    v_perm_b32 v6, v194, v190, s4
    v_perm_b32 v194, v194, v190, s5
    v_mov_b32 v190, v6
    v_perm_b32 v7, v195, v191, s4
    v_perm_b32 v195, v195, v191, s5
    v_mov_b32 v191, v7
    v_perm_b32 v6, v200, v196, s4
    v_perm_b32 v200, v200, v196, s5
    v_mov_b32 v196, v6
    v_perm_b32 v7, v201, v197, s4
    v_perm_b32 v201, v201, v197, s5
    v_mov_b32 v197, v7
    v_perm_b32 v6, v202, v198, s4
    v_perm_b32 v202, v202, v198, s5
    v_mov_b32 v198, v6
    v_perm_b32 v7, v203, v199, s4
    v_perm_b32 v203, v203, v199, s5
    v_mov_b32 v199, v7
    v_perm_b32 v6, v208, v204, s4
    v_perm_b32 v208, v208, v204, s5
    v_mov_b32 v204, v6
    v_perm_b32 v7, v209, v205, s4
    v_perm_b32 v209, v209, v205, s5
    v_mov_b32 v205, v7
    v_perm_b32 v6, v210, v206, s4
    v_perm_b32 v210, v210, v206, s5
    v_mov_b32 v206, v6
    v_perm_b32 v7, v211, v207, s4
    v_perm_b32 v211, v211, v207, s5
    v_mov_b32 v207, v7
    s_branch L_d_main
L_d_hi:
    v_mul_u32_u24 v3, 10240, v14
    v_lshl_add_u32 v3, v15, 4, v3
    s_sub_u32 s6, s3, 4
    s_mul_i32 s6, s6, 40960
    s_add_u32 s5, s5, s6
    s_add_u32 s5, s5, 1024
    buffer_load_dwordx4 v[84:87], v3, s[24:27], s5 offen offset:0 nt
    buffer_load_dwordx4 v[88:91], v3, s[24:27], s5 offen offset:1280 nt
    buffer_load_dwordx4 v[92:95], v3, s[24:27], s5 offen offset:2560 nt
    s_add_u32 s5, s5, 3840
    buffer_load_dwordx4 v[96:99], v3, s[24:27], s5 offen offset:0 nt
    buffer_load_dwordx4 v[100:103], v3, s[24:27], s5 offen offset:1280 nt
    buffer_load_dwordx4 v[104:107], v3, s[24:27], s5 offen offset:2560 nt
    s_add_u32 s5, s5, 3840
    buffer_load_dwordx4 v[108:111], v3, s[24:27], s5 offen offset:0 nt
    buffer_load_dwordx4 v[112:115], v3, s[24:27], s5 offen offset:1280 nt
    s_waitcnt vmcnt(0)
    s_mov_b32 s4, 0x05040100
    s_mov_b32 s5, 0x07060302
    v_perm_b32 v6, v24, v20, s4
    v_perm_b32 v24, v24, v20, s5
    v_mov_b32 v20, v6
    v_perm_b32 v7, v25, v21, s4
    v_perm_b32 v25, v25, v21, s5
    v_mov_b32 v21, v7
    v_perm_b32 v6, v26, v22, s4
    v_perm_b32 v26, v26, v22, s5
    v_mov_b32 v22, v6
    v_perm_b32 v7, v27, v23, s4
    v_perm_b32 v27, v27, v23, s5
    v_mov_b32 v23, v7
    v_perm_b32 v6, v32, v28, s4
    v_perm_b32 v32, v32, v28, s5
    v_mov_b32 v28, v6
    v_perm_b32 v7, v33, v29, s4
    v_perm_b32 v33, v33, v29, s5
    v_mov_b32 v29, v7
    v_perm_b32 v6, v34, v30, s4
    v_perm_b32 v34, v34, v30, s5
    v_mov_b32 v30, v6
    v_perm_b32 v7, v35, v31, s4
    v_perm_b32 v35, v35, v31, s5
    v_mov_b32 v31, v7
    v_perm_b32 v6, v40, v36, s4
    v_perm_b32 v40, v40, v36, s5
    v_mov_b32 v36, v6
    v_perm_b32 v7, v41, v37, s4
    v_perm_b32 v41, v41, v37, s5
    v_mov_b32 v37, v7
    v_perm_b32 v6, v42, v38, s4
    v_perm_b32 v42, v42, v38, s5
    v_mov_b32 v38, v6
    v_perm_b32 v7, v43, v39, s4
    v_perm_b32 v43, v43, v39, s5
    v_mov_b32 v39, v7
    v_perm_b32 v6, v48, v44, s4
    v_perm_b32 v48, v48, v44, s5
    v_mov_b32 v44, v6
    v_perm_b32 v7, v49, v45, s4
    v_perm_b32 v49, v49, v45, s5
    v_mov_b32 v45, v7
    v_perm_b32 v6, v50, v46, s4
    v_perm_b32 v50, v50, v46, s5
    v_mov_b32 v46, v6
    v_perm_b32 v7, v51, v47, s4
    v_perm_b32 v51, v51, v47, s5
    v_mov_b32 v47, v7
    v_perm_b32 v6, v56, v52, s4
    v_perm_b32 v56, v56, v52, s5
    v_mov_b32 v52, v6
    v_perm_b32 v7, v57, v53, s4
    v_perm_b32 v57, v57, v53, s5
    v_mov_b32 v53, v7
    v_perm_b32 v6, v58, v54, s4
    v_perm_b32 v58, v58, v54, s5
    v_mov_b32 v54, v6
    v_perm_b32 v7, v59, v55, s4
    v_perm_b32 v59, v59, v55, s5
    v_mov_b32 v55, v7
    v_perm_b32 v6, v64, v60, s4
    v_perm_b32 v64, v64, v60, s5
    v_mov_b32 v60, v6
    v_perm_b32 v7, v65, v61, s4
    v_perm_b32 v65, v65, v61, s5
    v_mov_b32 v61, v7
    v_perm_b32 v6, v66, v62, s4
    v_perm_b32 v66, v66, v62, s5
    v_mov_b32 v62, v6
    v_perm_b32 v7, v67, v63, s4
    v_perm_b32 v67, v67, v63, s5
    v_mov_b32 v63, v7
    v_perm_b32 v6, v72, v68, s4
    v_perm_b32 v72, v72, v68, s5
    v_mov_b32 v68, v6
    v_perm_b32 v7, v73, v69, s4
    v_perm_b32 v73, v73, v69, s5
    v_mov_b32 v69, v7
    v_perm_b32 v6, v74, v70, s4
    v_perm_b32 v74, v74, v70, s5
    v_mov_b32 v70, v6
    v_perm_b32 v7, v75, v71, s4
    v_perm_b32 v75, v75, v71, s5
    v_mov_b32 v71, v7
    v_perm_b32 v6, v80, v76, s4
    v_perm_b32 v80, v80, v76, s5
    v_mov_b32 v76, v6
    v_perm_b32 v7, v81, v77, s4
    v_perm_b32 v81, v81, v77, s5
    v_mov_b32 v77, v7
    v_perm_b32 v6, v82, v78, s4
    v_perm_b32 v82, v82, v78, s5
    v_mov_b32 v78, v6
    v_perm_b32 v7, v83, v79, s4
    v_perm_b32 v83, v83, v79, s5
    v_mov_b32 v79, v7
    v_perm_b32 v6, v88, v84, s4
    v_perm_b32 v88, v88, v84, s5
    v_mov_b32 v84, v6
    v_perm_b32 v7, v89, v85, s4
    v_perm_b32 v89, v89, v85, s5
    v_mov_b32 v85, v7
    v_perm_b32 v6, v90, v86, s4
    v_perm_b32 v90, v90, v86, s5
    v_mov_b32 v86, v6
    v_perm_b32 v7, v91, v87, s4
    v_perm_b32 v91, v91, v87, s5
    v_mov_b32 v87, v7
    v_perm_b32 v6, v96, v92, s4
    v_perm_b32 v96, v96, v92, s5
    v_mov_b32 v92, v6
    v_perm_b32 v7, v97, v93, s4
    v_perm_b32 v97, v97, v93, s5
    v_mov_b32 v93, v7
    v_perm_b32 v6, v98, v94, s4
    v_perm_b32 v98, v98, v94, s5
    v_mov_b32 v94, v6
    v_perm_b32 v7, v99, v95, s4
    v_perm_b32 v99, v99, v95, s5
    v_mov_b32 v95, v7
    v_perm_b32 v6, v104, v100, s4
    v_perm_b32 v104, v104, v100, s5
    v_mov_b32 v100, v6
    v_perm_b32 v7, v105, v101, s4
    v_perm_b32 v105, v105, v101, s5
    v_mov_b32 v101, v7
    v_perm_b32 v6, v106, v102, s4
    v_perm_b32 v106, v106, v102, s5
    v_mov_b32 v102, v6
    v_perm_b32 v7, v107, v103, s4
    v_perm_b32 v107, v107, v103, s5
    v_mov_b32 v103, v7
    v_perm_b32 v6, v112, v108, s4
    v_perm_b32 v112, v112, v108, s5
    v_mov_b32 v108, v6
    v_perm_b32 v7, v113, v109, s4
    v_perm_b32 v113, v113, v109, s5
    v_mov_b32 v109, v7
    v_perm_b32 v6, v114, v110, s4
    v_perm_b32 v114, v114, v110, s5
    v_mov_b32 v110, v6
    v_perm_b32 v7, v115, v111, s4
    v_perm_b32 v115, v115, v111, s5
    v_mov_b32 v111, v7
L_d_main:
    v_and_b32 v2, 31, v1
    v_lshlrev_b32 v2, 3, v2
    s_lshl_b32 s4, s43, 5
    s_add_u32 s4, s4, s42
    s_lshl_b32 s5, s4, 8
    s_add_u32 s5, s5, 327680
    s_cmp_lg_u32 s3, 4
    s_cbranch_scc1 L_nolp_46
    v_mov_b32 v12, v2
    v_lshlrev_b32 v2, 4, v1
    v_add_u32 v2, 5632, v2
    s_and_b32 exec_lo, s100, 0xffffffff
    s_mov_b32 exec_hi, 0
    s_cbranch_execz L_spin_47_x
    s_mov_b32 s98, 0
L_spin_47:
    buffer_load_dwordx4 v[4:7], v2, s[8:11], 0 offen sc1
    s_waitcnt vmcnt(0)
    v_xor_b32 v4, s96, v4
    v_xor_b32 v5, s97, v5
    v_xor_b32 v6, s96, v6
    v_xor_b32 v7, s97, v7
    v_or3_b32 v4, v4, v5, v6
    v_or_b32 v4, v4, v7
    v_cmp_ne_u32 vcc, 0, v4
    s_cbranch_vccz L_spd_48
    s_add_u32 s98, s98, 1
    s_cmp_gt_u32 s98, 200000
    s_cbranch_scc1 L_end
    s_sleep 1
    s_branch L_spin_47
L_spd_48:
L_spin_47_x:
    s_mov_b64 exec, s[100:101]
    v_mov_b32 v2, v12
    s_cbranch_execz L_lpd_50
    s_mov_b32 s98, 0
    buffer_load_dwordx2 v[120:121], v2, s[8:11], s5 offen sc1
    s_sleep 5
    buffer_load_dwordx2 v[122:123], v2, s[8:11], s5 offen sc1
    s_sleep 5
L_lp_49:
    buffer_load_dwordx2 v[124:125], v2, s[8:11], s5 offen sc1
    s_waitcnt vmcnt(2)
    v_max_u32 v126, v120, v121
    v_cmp_eq_u32 vcc, -1, v126
    s_bcnt1_i32_b64 s99, vcc
    s_cmp_le_u32 s99, 24
    s_cbranch_scc1 L_lpd_50
    buffer_load_dwordx2 v[120:121], v2, s[8:11], s5 offen sc1
    s_waitcnt vmcnt(2)
    v_max_u32 v126, v122, v123
    v_cmp_eq_u32 vcc, -1, v126
    s_bcnt1_i32_b64 s99, vcc
    s_cmp_le_u32 s99, 24
    s_cbranch_scc1 L_lpd_50
    buffer_load_dwordx2 v[122:123], v2, s[8:11], s5 offen sc1
    s_waitcnt vmcnt(2)
    v_max_u32 v126, v124, v125
    v_cmp_eq_u32 vcc, -1, v126
    s_bcnt1_i32_b64 s99, vcc
    s_cmp_le_u32 s99, 24
    s_cbranch_scc1 L_lpd_50
    s_add_u32 s98, s98, 1
    s_cmp_gt_u32 s98, 200000
    s_cbranch_scc1 L_end
    s_branch L_lp_49
L_lpd_50:
L_nolp_46:
    s_cmp_eq_u32 s100, 0
    s_cbranch_scc1 L_bar_51
    s_barrier
L_bar_51:
    s_cmp_lt_u32 s3, 4
    s_cbranch_scc1 L_noz_52
    v_lshlrev_b32 v3, 13, v14
    v_lshl_add_u32 v3, v15, 4, v3
    s_lshl_b32 s6, s4, 15
    s_sub_u32 s46, s3, 4
    s_lshl_b32 s7, s46, 8
    s_add_u32 s6, s6, s7
    s_add_u32 s48, s6, 1048576
    s_add_u32 s49, s48, 4096
    s_cbranch_execz L_spin_53_x
    s_mov_b32 s98, 0
L_spin_53:
    buffer_load_dwordx2 v[4:5], v2, s[8:11], s5 offen sc1
    buffer_load_dwordx4 v[164:167], v3, s[8:11], s48 offen offset:0 sc1
    buffer_load_dwordx4 v[168:171], v3, s[8:11], s48 offen offset:1024 sc1
    buffer_load_dwordx4 v[172:175], v3, s[8:11], s48 offen offset:2048 sc1
    buffer_load_dwordx4 v[176:179], v3, s[8:11], s48 offen offset:3072 sc1
    buffer_load_dwordx4 v[180:183], v3, s[8:11], s49 offen offset:0 sc1
    buffer_load_dwordx4 v[184:187], v3, s[8:11], s49 offen offset:1024 sc1
    buffer_load_dwordx4 v[188:191], v3, s[8:11], s49 offen offset:2048 sc1
    buffer_load_dwordx4 v[192:195], v3, s[8:11], s49 offen offset:3072 sc1
    s_waitcnt vmcnt(0)
    v_max3_u32 v6, v4, v5, v164
    v_max3_u32 v6, v6, v165, v166
    v_max3_u32 v6, v6, v167, v168
    v_max3_u32 v6, v6, v169, v170
    v_max3_u32 v6, v6, v171, v172
    v_max3_u32 v6, v6, v173, v174
    v_max3_u32 v6, v6, v175, v176
    v_max3_u32 v6, v6, v177, v178
    v_max3_u32 v6, v6, v179, v180
    v_max3_u32 v6, v6, v181, v182
    v_max3_u32 v6, v6, v183, v184
    v_max3_u32 v6, v6, v185, v186
    v_max3_u32 v6, v6, v187, v188
    v_max3_u32 v6, v6, v189, v190
    v_max3_u32 v6, v6, v191, v192
    v_max3_u32 v6, v6, v193, v194
    v_max_u32 v6, v6, v195
    v_cmp_eq_u32 vcc, -1, v6
    s_cbranch_vccz L_spd_54
    s_add_u32 s98, s98, 1
    s_cmp_gt_u32 s98, 200000
    s_cbranch_scc1 L_end
    s_sleep 1
    s_branch L_spin_53
L_spd_54:
L_spin_53_x:
    v_mov_b32 v6, v4
    s_nop 1
    v_max_f32_dpp v6, v6, v6 quad_perm:[1,0,3,2] row_mask:0xf bank_mask:0xf
    s_nop 1
    v_max_f32_dpp v6, v6, v6 quad_perm:[2,3,0,1] row_mask:0xf bank_mask:0xf
    s_nop 1
    v_max_f32_dpp v6, v6, v6 row_half_mirror row_mask:0xf bank_mask:0xf
    s_nop 1
    v_max_f32_dpp v6, v6, v6 row_mirror row_mask:0xf bank_mask:0xf
    v_mov_b32 v7, v6
    s_nop 1
    v_permlane16_swap_b32 v6, v7
    s_nop 0
    v_max_f32 v6, v6, v7
    v_sub_f32 v4, v4, v6
    v_exp_f32 v4, v4
    v_lshlrev_b32 v2, 2, v1
    s_add_u32 s7, s7, 45056
    v_add_u32 v2, s7, v2
    v_cvt_pk_bf16_f32 v8, v4, v4
    ds_write_b32 v2, v8
    v_and_b32 v4, 0xffff0000, v8
    v_mul_f32 v5, v4, v5
    v_lshlrev_b32 v2, 5, v14
    v_add_u32 v2, s7, v2
    s_waitcnt lgkmcnt(0)
    ds_read_b128 v[196:199], v2 offset:0
    ds_read_b128 v[200:203], v2 offset:16
    s_nop 1
    v_add_f32_dpp v5, v5, v5 quad_perm:[1,0,3,2] row_mask:0xf bank_mask:0xf
    s_nop 1
    v_add_f32_dpp v5, v5, v5 quad_perm:[2,3,0,1] row_mask:0xf bank_mask:0xf
    s_nop 1
    v_add_f32_dpp v5, v5, v5 row_half_mirror row_mask:0xf bank_mask:0xf
    s_nop 1
    v_add_f32_dpp v5, v5, v5 row_mirror row_mask:0xf bank_mask:0xf
    v_mov_b32 v7, v5
    s_nop 1
    v_permlane16_swap_b32 v5, v7
    s_nop 0
    v_add_f32 v5, v5, v7
    v_rcp_f32 v5, v5
    v_lshlrev_b32 v2, 4, v15
    v_lshl_add_u32 v2, v14, 3, v2
    s_lshl_b32 s4, s46, 8
    s_add_u32 s4, s4, 46080
    v_add_u32 v2, s4, v2
    s_waitcnt lgkmcnt(0)
    v_and_b32 v204, v16, v196
    v_and_b32 v205, v17, v196
    v_and_b32 v206, v18, v196
    v_and_b32 v207, v19, v196
    v_and_b32 v208, v16, v197
    v_and_b32 v209, v17, v197
    v_and_b32 v210, v18, v197
    v_and_b32 v211, v19, v197
    v_mfma_f32_16x16x32_bf16 v[8:11], v[204:207], v[164:167], 0
    v_and_b32 v204, v16, v198
    v_and_b32 v205, v17, v198
    v_and_b32 v206, v18, v198
    v_and_b32 v207, v19, v198
    v_mfma_f32_16x16x32_bf16 v[8:11], v[208:211], v[168:171], v[8:11]
    v_and_b32 v208, v16, v199
    v_and_b32 v209, v17, v199
    v_and_b32 v210, v18, v199
    v_and_b32 v211, v19, v199
    v_mfma_f32_16x16x32_bf16 v[8:11], v[204:207], v[172:175], v[8:11]
    v_and_b32 v204, v16, v200
    v_and_b32 v205, v17, v200
    v_and_b32 v206, v18, v200
    v_and_b32 v207, v19, v200
    v_mfma_f32_16x16x32_bf16 v[8:11], v[208:211], v[176:179], v[8:11]
    v_and_b32 v208, v16, v201
    v_and_b32 v209, v17, v201
    v_and_b32 v210, v18, v201
    v_and_b32 v211, v19, v201
    v_mfma_f32_16x16x32_bf16 v[8:11], v[204:207], v[180:183], v[8:11]
    v_and_b32 v204, v16, v202
    v_and_b32 v205, v17, v202
    v_and_b32 v206, v18, v202
    v_and_b32 v207, v19, v202
    v_mfma_f32_16x16x32_bf16 v[8:11], v[208:211], v[184:187], v[8:11]
    v_and_b32 v208, v16, v203
    v_and_b32 v209, v17, v203
    v_and_b32 v210, v18, v203
    v_and_b32 v211, v19, v203
    v_mfma_f32_16x16x32_bf16 v[8:11], v[204:207], v[188:191], v[8:11]
    s_nop 1
    v_mfma_f32_16x16x32_bf16 v[8:11], v[208:211], v[192:195], v[8:11]
    s_nop 8
    v_mul_f32 v8, v8, v5
    v_mul_f32 v9, v9, v5
    v_mul_f32 v10, v10, v5
    v_mul_f32 v11, v11, v5
    v_cvt_pk_bf16_f32 v8, v8, v9
    v_cvt_pk_bf16_f32 v9, v10, v11
    s_and_b32 exec_lo, s100, 0xffffffff
    s_mov_b32 exec_hi, 0
    ds_write_b64 v2, v[8:9]
    s_mov_b64 exec, s[100:101]
L_noz_52:
    v_lshlrev_b32 v2, 5, v14
    s_lshl_b32 s4, s3, 7
    s_add_u32 s4, s4, 46080
    v_add_u32 v2, s4, v2
    s_lshl_b32 s4, s3, 9
    s_add_u32 s4, s4, 49152
    v_add_u32 v3, s4, v13
    s_waitcnt lgkmcnt(0)
    s_cmp_eq_u32 s100, 0
    s_cbranch_scc1 L_bar_55
    s_barrier
L_bar_55:
    ds_read_b128 v[212:215], v2 offset:0
    ds_read_b128 v[216:219], v2 offset:16
    s_waitcnt lgkmcnt(0)
    v_and_b32 v228, v244, v212
    v_and_b32 v229, v245, v212
    v_and_b32 v230, v246, v212
    v_and_b32 v231, v247, v212
    v_and_b32 v232, v244, v213
    v_and_b32 v233, v245, v213
    v_and_b32 v234, v246, v213
    v_and_b32 v235, v247, v213
    v_mfma_f32_16x16x32_bf16 v[236:239], v[228:231], v[20:23], 0
    v_mfma_f32_16x16x32_bf16 v[240:243], v[228:231], v[24:27], 0
    v_and_b32 v228, v244, v214
    v_and_b32 v229, v245, v214
    v_and_b32 v230, v246, v214
    v_and_b32 v231, v247, v214
    v_mfma_f32_16x16x32_bf16 v[236:239], v[232:235], v[28:31], v[236:239]
    v_mfma_f32_16x16x32_bf16 v[240:243], v[232:235], v[32:35], v[240:243]
    v_and_b32 v232, v244, v215
    v_and_b32 v233, v245, v215
    v_and_b32 v234, v246, v215
    v_and_b32 v235, v247, v215
    v_mfma_f32_16x16x32_bf16 v[236:239], v[228:231], v[36:39], v[236:239]
    v_mfma_f32_16x16x32_bf16 v[240:243], v[228:231], v[40:43], v[240:243]
    v_and_b32 v228, v244, v216
    v_and_b32 v229, v245, v216
    v_and_b32 v230, v246, v216
    v_and_b32 v231, v247, v216
    v_mfma_f32_16x16x32_bf16 v[236:239], v[232:235], v[44:47], v[236:239]
    v_mfma_f32_16x16x32_bf16 v[240:243], v[232:235], v[48:51], v[240:243]
    v_and_b32 v232, v244, v217
    v_and_b32 v233, v245, v217
    v_and_b32 v234, v246, v217
    v_and_b32 v235, v247, v217
    v_mfma_f32_16x16x32_bf16 v[236:239], v[228:231], v[52:55], v[236:239]
    v_mfma_f32_16x16x32_bf16 v[240:243], v[228:231], v[56:59], v[240:243]
    v_and_b32 v228, v244, v218
    v_and_b32 v229, v245, v218
    v_and_b32 v230, v246, v218
    v_and_b32 v231, v247, v218
    v_mfma_f32_16x16x32_bf16 v[236:239], v[232:235], v[60:63], v[236:239]
    v_mfma_f32_16x16x32_bf16 v[240:243], v[232:235], v[64:67], v[240:243]
    v_and_b32 v232, v244, v219
    v_and_b32 v233, v245, v219
    v_and_b32 v234, v246, v219
    v_and_b32 v235, v247, v219
    v_mfma_f32_16x16x32_bf16 v[236:239], v[228:231], v[68:71], v[236:239]
    v_mfma_f32_16x16x32_bf16 v[240:243], v[228:231], v[72:75], v[240:243]
    s_nop 1
    v_mfma_f32_16x16x32_bf16 v[236:239], v[232:235], v[76:79], v[236:239]
    v_mfma_f32_16x16x32_bf16 v[240:243], v[232:235], v[80:83], v[240:243]
    s_nop 8
    s_and_b32 exec_lo, s100, 0xffff
    s_mov_b32 exec_hi, 0
    ds_write_b128 v3, v[236:239]
    ds_write_b128 v3, v[240:243] offset:256
    s_mov_b64 exec, s[100:101]
    s_waitcnt lgkmcnt(0)
    s_cmp_eq_u32 s100, 0
    s_cbranch_scc1 L_bar_56
    s_barrier
L_bar_56:
    s_cmp_lg_u32 s3, 0
    s_cbranch_scc1 L_nored_57
    v_lshlrev_b32 v3, 3, v1
    v_add_u32 v3, 49152, v3
    v_add_u32 v2, 2048, v3
    s_and_b32 exec_lo, s100, 0xffffffff
    s_mov_b32 exec_hi, 0
    ds_read2_b64 v[20:23], v3 offset0:0 offset1:32
    ds_read2_b64 v[24:27], v3 offset0:64 offset1:96
    ds_read2_b64 v[28:31], v3 offset0:128 offset1:160
    ds_read2_b64 v[32:35], v3 offset0:192 offset1:224
    ds_read2_b64 v[36:39], v2 offset0:0 offset1:32
    ds_read2_b64 v[40:43], v2 offset0:64 offset1:96
    ds_read2_b64 v[44:47], v2 offset0:128 offset1:160
    ds_read2_b64 v[48:51], v2 offset0:192 offset1:224
    v_lshlrev_b32 v3, 3, v1
    v_add_u32 v3, 46080, v3
    s_waitcnt lgkmcnt(0)
    v_pk_add_f32 v[20:21], v[20:21], v[24:25]
    v_pk_add_f32 v[22:23], v[22:23], v[26:27]
    v_pk_add_f32 v[28:29], v[28:29], v[32:33]
    v_pk_add_f32 v[30:31], v[30:31], v[34:35]
    v_pk_add_f32 v[36:37], v[36:37], v[40:41]
    v_pk_add_f32 v[38:39], v[38:39], v[42:43]
    v_pk_add_f32 v[44:45], v[44:45], v[48:49]
    v_pk_add_f32 v[46:47], v[46:47], v[50:51]
    v_pk_add_f32 v[20:21], v[20:21], v[28:29]
    v_pk_add_f32 v[22:23], v[22:23], v[30:31]
    v_pk_add_f32 v[36:37], v[36:37], v[44:45]
    v_pk_add_f32 v[38:39], v[38:39], v[46:47]
    v_pk_add_f32 v[20:21], v[20:21], v[36:37]
    v_pk_add_f32 v[22:23], v[22:23], v[38:39]
    v_cvt_pk_bf16_f32 v20, v20, v22
    v_cvt_pk_bf16_f32 v21, v21, v23
    ds_write_b64 v3, v[20:21]
    s_mov_b64 exec, s[100:101]
    s_waitcnt lgkmcnt(0)
L_nored_57:
    s_lshl_b32 s4, s43, 5
    s_add_u32 s4, s4, s42
    s_mul_i32 s4, s4, 1280
    s_add_u32 s4, s4, 360448
    s_cmp_eq_u32 s100, 0
    s_cbranch_scc1 L_bar_58
    s_barrier
L_bar_58:
    s_cmp_gt_u32 s3, 3
    s_cbranch_scc1 L_d_hi2
    v_lshlrev_b32 v2, 6, v14
    v_add_u32 v2, 46080, v2
    ds_read_b128 v[212:215], v2 offset:0
    ds_read_b128 v[216:219], v2 offset:16
    ds_read_b128 v[220:223], v2 offset:32
    ds_read_b128 v[224:227], v2 offset:48
    s_lshl_b32 s5, s3, 8
    s_add_u32 s4, s4, s5
    s_waitcnt lgkmcnt(0)
    v_and_b32 v228, v244, v212
    v_and_b32 v229, v245, v212
    v_and_b32 v230, v246, v212
    v_and_b32 v231, v247, v212
    v_and_b32 v232, v244, v213
    v_and_b32 v233, v245, v213
    v_and_b32 v234, v246, v213
    v_and_b32 v235, v247, v213
    v_mfma_f32_16x16x32_bf16 v[236:239], v[228:231], v[84:87], 0
    v_mfma_f32_16x16x32_bf16 v[240:243], v[228:231], v[88:91], 0
    v_and_b32 v228, v244, v214
    v_and_b32 v229, v245, v214
    v_and_b32 v230, v246, v214
    v_and_b32 v231, v247, v214
    v_mfma_f32_16x16x32_bf16 v[236:239], v[232:235], v[92:95], v[236:239]
    v_mfma_f32_16x16x32_bf16 v[240:243], v[232:235], v[96:99], v[240:243]
    v_and_b32 v232, v244, v215
    v_and_b32 v233, v245, v215
    v_and_b32 v234, v246, v215
    v_and_b32 v235, v247, v215
    v_mfma_f32_16x16x32_bf16 v[236:239], v[228:231], v[100:103], v[236:239]
    v_mfma_f32_16x16x32_bf16 v[240:243], v[228:231], v[104:107], v[240:243]
    v_and_b32 v228, v244, v216
    v_and_b32 v229, v245, v216
    v_and_b32 v230, v246, v216
    v_and_b32 v231, v247, v216
    v_mfma_f32_16x16x32_bf16 v[236:239], v[232:235], v[108:111], v[236:239]
    v_mfma_f32_16x16x32_bf16 v[240:243], v[232:235], v[112:115], v[240:243]
    v_and_b32 v232, v244, v217
    v_and_b32 v233, v245, v217
    v_and_b32 v234, v246, v217
    v_and_b32 v235, v247, v217
    v_mfma_f32_16x16x32_bf16 v[236:239], v[228:231], v[116:119], v[236:239]
    v_mfma_f32_16x16x32_bf16 v[240:243], v[228:231], v[120:123], v[240:243]
    v_and_b32 v228, v244, v218
    v_and_b32 v229, v245, v218
    v_and_b32 v230, v246, v218
    v_and_b32 v231, v247, v218
    v_mfma_f32_16x16x32_bf16 v[236:239], v[232:235], v[124:127], v[236:239]
    v_mfma_f32_16x16x32_bf16 v[240:243], v[232:235], v[128:131], v[240:243]
    v_and_b32 v232, v244, v219
    v_and_b32 v233, v245, v219
    v_and_b32 v234, v246, v219
    v_and_b32 v235, v247, v219
    v_mfma_f32_16x16x32_bf16 v[236:239], v[228:231], v[132:135], v[236:239]
    v_mfma_f32_16x16x32_bf16 v[240:243], v[228:231], v[136:139], v[240:243]
    v_and_b32 v228, v244, v220
    v_and_b32 v229, v245, v220
    v_and_b32 v230, v246, v220
    v_and_b32 v231, v247, v220
    v_mfma_f32_16x16x32_bf16 v[236:239], v[232:235], v[140:143], v[236:239]
    v_mfma_f32_16x16x32_bf16 v[240:243], v[232:235], v[144:147], v[240:243]
    v_and_b32 v232, v244, v221
    v_and_b32 v233, v245, v221
    v_and_b32 v234, v246, v221
    v_and_b32 v235, v247, v221
    v_mfma_f32_16x16x32_bf16 v[236:239], v[228:231], v[148:151], v[236:239]
    v_mfma_f32_16x16x32_bf16 v[240:243], v[228:231], v[152:155], v[240:243]
    v_and_b32 v228, v244, v222
    v_and_b32 v229, v245, v222
    v_and_b32 v230, v246, v222
    v_and_b32 v231, v247, v222
    v_mfma_f32_16x16x32_bf16 v[236:239], v[232:235], v[156:159], v[236:239]
    v_mfma_f32_16x16x32_bf16 v[240:243], v[232:235], v[160:163], v[240:243]
    v_and_b32 v232, v244, v223
    v_and_b32 v233, v245, v223
    v_and_b32 v234, v246, v223
    v_and_b32 v235, v247, v223
    v_mfma_f32_16x16x32_bf16 v[236:239], v[228:231], v[164:167], v[236:239]
    v_mfma_f32_16x16x32_bf16 v[240:243], v[228:231], v[168:171], v[240:243]
    v_and_b32 v228, v244, v224
    v_and_b32 v229, v245, v224
    v_and_b32 v230, v246, v224
    v_and_b32 v231, v247, v224
    v_mfma_f32_16x16x32_bf16 v[236:239], v[232:235], v[172:175], v[236:239]
    v_mfma_f32_16x16x32_bf16 v[240:243], v[232:235], v[176:179], v[240:243]
    v_and_b32 v232, v244, v225
    v_and_b32 v233, v245, v225
    v_and_b32 v234, v246, v225
    v_and_b32 v235, v247, v225
    v_mfma_f32_16x16x32_bf16 v[236:239], v[228:231], v[180:183], v[236:239]
    v_mfma_f32_16x16x32_bf16 v[240:243], v[228:231], v[184:187], v[240:243]
    v_and_b32 v228, v244, v226
    v_and_b32 v229, v245, v226
    v_and_b32 v230, v246, v226
    v_and_b32 v231, v247, v226
    v_mfma_f32_16x16x32_bf16 v[236:239], v[232:235], v[188:191], v[236:239]
    v_mfma_f32_16x16x32_bf16 v[240:243], v[232:235], v[192:195], v[240:243]
    v_and_b32 v232, v244, v227
    v_and_b32 v233, v245, v227
    v_and_b32 v234, v246, v227
    v_and_b32 v235, v247, v227
    v_mfma_f32_16x16x32_bf16 v[236:239], v[228:231], v[196:199], v[236:239]
    v_mfma_f32_16x16x32_bf16 v[240:243], v[228:231], v[200:203], v[240:243]
    s_nop 1
    v_mfma_f32_16x16x32_bf16 v[236:239], v[232:235], v[204:207], v[236:239]
    v_mfma_f32_16x16x32_bf16 v[240:243], v[232:235], v[208:211], v[240:243]
    s_nop 8
    v_cvt_pk_bf16_f32 v236, v236, v240
    v_min_u32 v236, 0xfffffffe, v236
    v_cvt_pk_bf16_f32 v237, v237, v241
    v_min_u32 v237, 0xfffffffe, v237
    v_cvt_pk_bf16_f32 v238, v238, v242
    v_min_u32 v238, 0xfffffffe, v238
    v_cvt_pk_bf16_f32 v239, v239, v243
    v_min_u32 v239, 0xfffffffe, v239
    s_and_b32 exec_lo, s100, 0xffff
    s_mov_b32 exec_hi, 0
    buffer_store_dwordx4 v[236:239], v13, s[8:11], s4 offen sc1
    s_mov_b64 exec, s[100:101]
    s_cmp_eq_u32 s100, 0
    s_cbranch_scc1 L_bar_59
    s_barrier
L_bar_59:
    s_branch L_end
L_d_hi2:
    v_lshlrev_b32 v2, 4, v14
    s_lshl_b32 s5, s46, 6
    s_add_u32 s5, s5, 46080
    v_add_u32 v2, s5, v2
    ds_read_b128 v[212:215], v2
    s_lshl_b32 s5, s46, 9
    s_add_u32 s5, s5, 49152
    v_add_u32 v3, s5, v13
    s_waitcnt lgkmcnt(0)
    v_and_b32 v228, v244, v212
    v_and_b32 v229, v245, v212
    v_and_b32 v230, v246, v212
    v_and_b32 v231, v247, v212
    v_and_b32 v232, v244, v213
    v_and_b32 v233, v245, v213
    v_and_b32 v234, v246, v213
    v_and_b32 v235, v247, v213
    v_mfma_f32_16x16x32_bf16 v[236:239], v[228:231], v[84:87], 0
    v_mfma_f32_16x16x32_bf16 v[240:243], v[228:231], v[88:91], 0
    v_and_b32 v228, v244, v214
    v_and_b32 v229, v245, v214
    v_and_b32 v230, v246, v214
    v_and_b32 v231, v247, v214
    v_mfma_f32_16x16x32_bf16 v[236:239], v[232:235], v[92:95], v[236:239]
    v_mfma_f32_16x16x32_bf16 v[240:243], v[232:235], v[96:99], v[240:243]
    v_and_b32 v232, v244, v215
    v_and_b32 v233, v245, v215
    v_and_b32 v234, v246, v215
    v_and_b32 v235, v247, v215
    v_mfma_f32_16x16x32_bf16 v[236:239], v[228:231], v[100:103], v[236:239]
    v_mfma_f32_16x16x32_bf16 v[240:243], v[228:231], v[104:107], v[240:243]
    s_nop 1
    v_mfma_f32_16x16x32_bf16 v[236:239], v[232:235], v[108:111], v[236:239]
    v_mfma_f32_16x16x32_bf16 v[240:243], v[232:235], v[112:115], v[240:243]
    s_nop 8
    s_and_b32 exec_lo, s100, 0xffff
    s_mov_b32 exec_hi, 0
    ds_write_b128 v3, v[236:239]
    ds_write_b128 v3, v[240:243] offset:256
    s_mov_b64 exec, s[100:101]
    s_waitcnt lgkmcnt(0)
    s_cmp_eq_u32 s100, 0
    s_cbranch_scc1 L_bar_60
    s_barrier
L_bar_60:
    s_cmp_lg_u32 s3, 4
    s_cbranch_scc1 L_end
    v_add_u32 v3, 49152, v13
    s_and_b32 exec_lo, s100, 0xffff
    s_mov_b32 exec_hi, 0
    ds_read_b128 v[20:23], v3 offset:0
    ds_read_b128 v[24:27], v3 offset:256
    ds_read_b128 v[28:31], v3 offset:512
    ds_read_b128 v[32:35], v3 offset:768
    ds_read_b128 v[36:39], v3 offset:1024
    ds_read_b128 v[40:43], v3 offset:1280
    ds_read_b128 v[44:47], v3 offset:1536
    ds_read_b128 v[48:51], v3 offset:1792
    s_waitcnt lgkmcnt(0)
    v_pk_add_f32 v[20:21], v[20:21], v[28:29]
    v_pk_add_f32 v[36:37], v[36:37], v[44:45]
    v_pk_add_f32 v[20:21], v[20:21], v[36:37]
    v_pk_add_f32 v[22:23], v[22:23], v[30:31]
    v_pk_add_f32 v[38:39], v[38:39], v[46:47]
    v_pk_add_f32 v[22:23], v[22:23], v[38:39]
    v_pk_add_f32 v[24:25], v[24:25], v[32:33]
    v_pk_add_f32 v[40:41], v[40:41], v[48:49]
    v_pk_add_f32 v[24:25], v[24:25], v[40:41]
    v_pk_add_f32 v[26:27], v[26:27], v[34:35]
    v_pk_add_f32 v[42:43], v[42:43], v[50:51]
    v_pk_add_f32 v[26:27], v[26:27], v[42:43]
    v_cvt_pk_bf16_f32 v20, v20, v24
    v_min_u32 v20, 0xfffffffe, v20
    v_cvt_pk_bf16_f32 v21, v21, v25
    v_min_u32 v21, 0xfffffffe, v21
    v_cvt_pk_bf16_f32 v22, v22, v26
    v_min_u32 v22, 0xfffffffe, v22
    v_cvt_pk_bf16_f32 v23, v23, v27
    v_min_u32 v23, 0xfffffffe, v23
    buffer_store_dwordx4 v[20:23], v13, s[8:11], s4 offen offset:1024 sc1
    s_mov_b64 exec, s[100:101]
    s_branch L_end
L_role_e:
    s_mov_b32 s20, s78
    s_and_b32 s21, s79, 0xffff
    s_mov_b32 s22, 2211840
    s_mov_b32 s23, 0x00020000
    s_mov_b32 s24, s80
    s_and_b32 s25, s81, 0xffff
    s_mov_b32 s26, 2211840
    s_mov_b32 s27, 0x00020000
    s_mov_b32 s28, s82
    s_and_b32 s29, s83, 0xffff
    s_mov_b32 s30, 2211840
    s_mov_b32 s31, 0x00020000
    s_mov_b32 s32, s64
    s_and_b32 s33, s65, 0xffff
    s_mov_b32 s34, 2560
    s_mov_b32 s35, 0x00020000
    s_mov_b32 s36, s88
    s_and_b32 s37, s89, 0xffff
    s_mov_b32 s38, 2560
    s_mov_b32 s39, 0x00020000
    v_and_b32 v2, 1, v1
    v_cmp_eq_u32 vcc, 1, v2
    v_mov_b32 v3, 0xffff
    v_mov_b32 v2, 0xffff0000
    s_nop 0
    v_cndmask_b32 v3, v3, v2, vcc
    v_and_b32 v2, 8, v1
    v_cmp_eq_u32 vcc, 0, v2
    s_nop 1
    v_cndmask_b32 v3, 0, v3, vcc
    v_bfe_u32 v2, v1, 1, 2
    v_cmp_eq_u32 vcc, 0, v2
    s_nop 1
    v_cndmask_b32 v16, 0, v3, vcc
    v_cmp_eq_u32 vcc, 1, v2
    s_nop 1
    v_cndmask_b32 v17, 0, v3, vcc
    v_cmp_eq_u32 vcc, 2, v2
    s_nop 1
    v_cndmask_b32 v18, 0, v3, vcc
    v_cmp_eq_u32 vcc, 3, v2
    s_nop 1
    v_cndmask_b32 v19, 0, v3, vcc
    v_bfe_u32 v2, v1, 2, 2
    v_cmp_gt_u32 vcc, 1, v2
    s_nop 1
    v_cndmask_b32 v3, 0, -1, vcc
    v_and_b32 v2, 3, v1
    v_cmp_eq_u32 vcc, 0, v2
    s_nop 1
    v_cndmask_b32 v240, 0, v3, vcc
    v_cmp_eq_u32 vcc, 1, v2
    s_nop 1
    v_cndmask_b32 v241, 0, v3, vcc
    v_cmp_eq_u32 vcc, 2, v2
    s_nop 1
    v_cndmask_b32 v242, 0, v3, vcc
    v_cmp_eq_u32 vcc, 3, v2
    s_nop 1
    v_cndmask_b32 v243, 0, v3, vcc
L_e_init:
    s_cmp_lg_u32 s47, 0
    s_cbranch_scc1 L_end
    v_mul_u32_u24 v2, 69120, v14
    v_and_b32 v3, 7, v15
    v_lshl_add_u32 v2, v3, 4, v2
    s_mul_i32 s4, s3, 276480
    s_lshl_b32 s5, s42, 7
    s_add_u32 s4, s4, s5
    s_mov_b32 s6, 0x00ff00ff
    s_mov_b32 s7, 0x00ff00ff
    s_mov_b32 s48, 0xff00ff00
    s_mov_b32 s49, 0xff00ff00
    s_mov_b64 exec, s[6:7]
    buffer_load_dwordx4 v[20:23], v2, s[20:23], s4 offen nt
    s_mov_b64 exec, s[48:49]
    buffer_load_dwordx4 v[20:23], v2, s[24:27], s4 offen nt
    s_add_u32 s4, s4, 3456
    s_mov_b64 exec, s[6:7]
    buffer_load_dwordx4 v[24:27], v2, s[20:23], s4 offen nt
    s_mov_b64 exec, s[48:49]
    buffer_load_dwordx4 v[24:27], v2, s[24:27], s4 offen nt
    s_add_u32 s4, s4, 3456
    s_mov_b64 exec, s[6:7]
    buffer_load_dwordx4 v[28:31], v2, s[20:23], s4 offen nt
    s_mov_b64 exec, s[48:49]
    buffer_load_dwordx4 v[28:31], v2, s[24:27], s4 offen nt
    s_add_u32 s4, s4, 3456
    s_mov_b64 exec, s[6:7]
    buffer_load_dwordx4 v[32:35], v2, s[20:23], s4 offen nt
    s_mov_b64 exec, s[48:49]
    buffer_load_dwordx4 v[32:35], v2, s[24:27], s4 offen nt
    s_add_u32 s4, s4, 3456
    s_mov_b64 exec, s[6:7]
    buffer_load_dwordx4 v[36:39], v2, s[20:23], s4 offen nt
    s_mov_b64 exec, s[48:49]
    buffer_load_dwordx4 v[36:39], v2, s[24:27], s4 offen nt
    s_add_u32 s4, s4, 3456
    s_mov_b64 exec, s[6:7]
    buffer_load_dwordx4 v[40:43], v2, s[20:23], s4 offen nt
    s_mov_b64 exec, s[48:49]
    buffer_load_dwordx4 v[40:43], v2, s[24:27], s4 offen nt
    s_add_u32 s4, s4, 3456
    s_mov_b64 exec, s[6:7]
    buffer_load_dwordx4 v[44:47], v2, s[20:23], s4 offen nt
    s_mov_b64 exec, s[48:49]
    buffer_load_dwordx4 v[44:47], v2, s[24:27], s4 offen nt
    s_add_u32 s4, s4, 3456
    s_mov_b64 exec, s[6:7]
    buffer_load_dwordx4 v[48:51], v2, s[20:23], s4 offen nt
    s_mov_b64 exec, s[48:49]
    buffer_load_dwordx4 v[48:51], v2, s[24:27], s4 offen nt
    s_add_u32 s4, s4, 3456
    s_mov_b64 exec, s[6:7]
    buffer_load_dwordx4 v[52:55], v2, s[20:23], s4 offen nt
    s_mov_b64 exec, s[48:49]
    buffer_load_dwordx4 v[52:55], v2, s[24:27], s4 offen nt
    s_add_u32 s4, s4, 3456
    s_mov_b64 exec, s[6:7]
    buffer_load_dwordx4 v[56:59], v2, s[20:23], s4 offen nt
    s_mov_b64 exec, s[48:49]
    buffer_load_dwordx4 v[56:59], v2, s[24:27], s4 offen nt
    s_add_u32 s4, s4, 3456
    s_mov_b64 exec, s[6:7]
    buffer_load_dwordx4 v[60:63], v2, s[20:23], s4 offen nt
    s_mov_b64 exec, s[48:49]
    buffer_load_dwordx4 v[60:63], v2, s[24:27], s4 offen nt
    s_add_u32 s4, s4, 3456
    s_mov_b64 exec, s[6:7]
    buffer_load_dwordx4 v[64:67], v2, s[20:23], s4 offen nt
    s_mov_b64 exec, s[48:49]
    buffer_load_dwordx4 v[64:67], v2, s[24:27], s4 offen nt
    s_add_u32 s4, s4, 3456
    s_mov_b64 exec, s[6:7]
    buffer_load_dwordx4 v[68:71], v2, s[20:23], s4 offen nt
    s_mov_b64 exec, s[48:49]
    buffer_load_dwordx4 v[68:71], v2, s[24:27], s4 offen nt
    s_add_u32 s4, s4, 3456
    s_mov_b64 exec, s[6:7]
    buffer_load_dwordx4 v[72:75], v2, s[20:23], s4 offen nt
    s_mov_b64 exec, s[48:49]
    buffer_load_dwordx4 v[72:75], v2, s[24:27], s4 offen nt
    s_add_u32 s4, s4, 3456
    s_mov_b64 exec, s[6:7]
    buffer_load_dwordx4 v[76:79], v2, s[20:23], s4 offen nt
    s_mov_b64 exec, s[48:49]
    buffer_load_dwordx4 v[76:79], v2, s[24:27], s4 offen nt
    s_add_u32 s4, s4, 3456
    s_mov_b64 exec, s[6:7]
    buffer_load_dwordx4 v[80:83], v2, s[20:23], s4 offen nt
    s_mov_b64 exec, s[48:49]
    buffer_load_dwordx4 v[80:83], v2, s[24:27], s4 offen nt
    s_add_u32 s4, s4, 3456
    s_mov_b64 exec, s[6:7]
    buffer_load_dwordx4 v[84:87], v2, s[20:23], s4 offen nt
    s_mov_b64 exec, s[48:49]
    buffer_load_dwordx4 v[84:87], v2, s[24:27], s4 offen nt
    s_add_u32 s4, s4, 3456
    s_mov_b64 exec, s[6:7]
    buffer_load_dwordx4 v[88:91], v2, s[20:23], s4 offen nt
    s_mov_b64 exec, s[48:49]
    buffer_load_dwordx4 v[88:91], v2, s[24:27], s4 offen nt
    s_add_u32 s4, s4, 3456
    s_mov_b64 exec, s[6:7]
    buffer_load_dwordx4 v[92:95], v2, s[20:23], s4 offen nt
    s_mov_b64 exec, s[48:49]
    buffer_load_dwordx4 v[92:95], v2, s[24:27], s4 offen nt
    s_add_u32 s4, s4, 3456
    s_mov_b64 exec, s[6:7]
    buffer_load_dwordx4 v[96:99], v2, s[20:23], s4 offen nt
    s_mov_b64 exec, s[48:49]
    buffer_load_dwordx4 v[96:99], v2, s[24:27], s4 offen nt
    s_mov_b64 exec, s[100:101]
    s_mul_i32 s4, s42, 81920
    s_cmp_gt_u32 s3, 3
    s_cbranch_scc1 L_e_hi
    v_mul_u32_u24 v2, 20480, v14
    v_lshl_add_u32 v2, v15, 4, v2
    s_lshl_b32 s5, s3, 8
    s_add_u32 s4, s4, s5
    buffer_load_dwordx4 v[100:103], v2, s[28:31], s4 offen nt
    s_add_u32 s4, s4, 1280
    buffer_load_dwordx4 v[104:107], v2, s[28:31], s4 offen nt
    s_add_u32 s4, s4, 1280
    buffer_load_dwordx4 v[108:111], v2, s[28:31], s4 offen nt
    s_add_u32 s4, s4, 1280
    buffer_load_dwordx4 v[112:115], v2, s[28:31], s4 offen nt
    s_add_u32 s4, s4, 1280
    buffer_load_dwordx4 v[116:119], v2, s[28:31], s4 offen nt
    s_add_u32 s4, s4, 1280
    buffer_load_dwordx4 v[120:123], v2, s[28:31], s4 offen nt
    s_add_u32 s4, s4, 1280
    buffer_load_dwordx4 v[124:127], v2, s[28:31], s4 offen nt
    s_add_u32 s4, s4, 1280
    buffer_load_dwordx4 v[128:131], v2, s[28:31], s4 offen nt
    s_add_u32 s4, s4, 1280
    buffer_load_dwordx4 v[132:135], v2, s[28:31], s4 offen nt
    s_add_u32 s4, s4, 1280
    buffer_load_dwordx4 v[136:139], v2, s[28:31], s4 offen nt
    s_add_u32 s4, s4, 1280
    buffer_load_dwordx4 v[140:143], v2, s[28:31], s4 offen nt
    s_add_u32 s4, s4, 1280
    buffer_load_dwordx4 v[144:147], v2, s[28:31], s4 offen nt
    s_add_u32 s4, s4, 1280
    buffer_load_dwordx4 v[148:151], v2, s[28:31], s4 offen nt
    s_add_u32 s4, s4, 1280
    buffer_load_dwordx4 v[152:155], v2, s[28:31], s4 offen nt
    s_add_u32 s4, s4, 1280
    buffer_load_dwordx4 v[156:159], v2, s[28:31], s4 offen nt
    s_add_u32 s4, s4, 1280
    buffer_load_dwordx4 v[160:163], v2, s[28:31], s4 offen nt
    s_waitcnt vmcnt(0)
    s_mov_b32 s4, 0x05040100
    s_mov_b32 s5, 0x07060302
    v_perm_b32 v6, v24, v20, s4
    v_perm_b32 v24, v24, v20, s5
    v_mov_b32 v20, v6
    v_perm_b32 v7, v25, v21, s4
    v_perm_b32 v25, v25, v21, s5
    v_mov_b32 v21, v7
    v_perm_b32 v6, v26, v22, s4
    v_perm_b32 v26, v26, v22, s5
    v_mov_b32 v22, v6
    v_perm_b32 v7, v27, v23, s4
    v_perm_b32 v27, v27, v23, s5
    v_mov_b32 v23, v7
    v_perm_b32 v6, v32, v28, s4
    v_perm_b32 v32, v32, v28, s5
    v_mov_b32 v28, v6
    v_perm_b32 v7, v33, v29, s4
    v_perm_b32 v33, v33, v29, s5
    v_mov_b32 v29, v7
    v_perm_b32 v6, v34, v30, s4
    v_perm_b32 v34, v34, v30, s5
    v_mov_b32 v30, v6
    v_perm_b32 v7, v35, v31, s4
    v_perm_b32 v35, v35, v31, s5
    v_mov_b32 v31, v7
    v_perm_b32 v6, v40, v36, s4
    v_perm_b32 v40, v40, v36, s5
    v_mov_b32 v36, v6
    v_perm_b32 v7, v41, v37, s4
    v_perm_b32 v41, v41, v37, s5
    v_mov_b32 v37, v7
    v_perm_b32 v6, v42, v38, s4
    v_perm_b32 v42, v42, v38, s5
    v_mov_b32 v38, v6
    v_perm_b32 v7, v43, v39, s4
    v_perm_b32 v43, v43, v39, s5
    v_mov_b32 v39, v7
    v_perm_b32 v6, v48, v44, s4
    v_perm_b32 v48, v48, v44, s5
    v_mov_b32 v44, v6
    v_perm_b32 v7, v49, v45, s4
    v_perm_b32 v49, v49, v45, s5
    v_mov_b32 v45, v7
    v_perm_b32 v6, v50, v46, s4
    v_perm_b32 v50, v50, v46, s5
    v_mov_b32 v46, v6
    v_perm_b32 v7, v51, v47, s4
    v_perm_b32 v51, v51, v47, s5
    v_mov_b32 v47, v7
    v_perm_b32 v6, v56, v52, s4
    v_perm_b32 v56, v56, v52, s5
    v_mov_b32 v52, v6
    v_perm_b32 v7, v57, v53, s4
    v_perm_b32 v57, v57, v53, s5
    v_mov_b32 v53, v7
    v_perm_b32 v6, v58, v54, s4
    v_perm_b32 v58, v58, v54, s5
    v_mov_b32 v54, v6
    v_perm_b32 v7, v59, v55, s4
    v_perm_b32 v59, v59, v55, s5
    v_mov_b32 v55, v7
    v_perm_b32 v6, v64, v60, s4
    v_perm_b32 v64, v64, v60, s5
    v_mov_b32 v60, v6
    v_perm_b32 v7, v65, v61, s4
    v_perm_b32 v65, v65, v61, s5
    v_mov_b32 v61, v7
    v_perm_b32 v6, v66, v62, s4
    v_perm_b32 v66, v66, v62, s5
    v_mov_b32 v62, v6
    v_perm_b32 v7, v67, v63, s4
    v_perm_b32 v67, v67, v63, s5
    v_mov_b32 v63, v7
    v_perm_b32 v6, v72, v68, s4
    v_perm_b32 v72, v72, v68, s5
    v_mov_b32 v68, v6
    v_perm_b32 v7, v73, v69, s4
    v_perm_b32 v73, v73, v69, s5
    v_mov_b32 v69, v7
    v_perm_b32 v6, v74, v70, s4
    v_perm_b32 v74, v74, v70, s5
    v_mov_b32 v70, v6
    v_perm_b32 v7, v75, v71, s4
    v_perm_b32 v75, v75, v71, s5
    v_mov_b32 v71, v7
    v_perm_b32 v6, v80, v76, s4
    v_perm_b32 v80, v80, v76, s5
    v_mov_b32 v76, v6
    v_perm_b32 v7, v81, v77, s4
    v_perm_b32 v81, v81, v77, s5
    v_mov_b32 v77, v7
    v_perm_b32 v6, v82, v78, s4
    v_perm_b32 v82, v82, v78, s5
    v_mov_b32 v78, v6
    v_perm_b32 v7, v83, v79, s4
    v_perm_b32 v83, v83, v79, s5
    v_mov_b32 v79, v7
    v_perm_b32 v6, v88, v84, s4
    v_perm_b32 v88, v88, v84, s5
    v_mov_b32 v84, v6
    v_perm_b32 v7, v89, v85, s4
    v_perm_b32 v89, v89, v85, s5
    v_mov_b32 v85, v7
    v_perm_b32 v6, v90, v86, s4
    v_perm_b32 v90, v90, v86, s5
    v_mov_b32 v86, v6
    v_perm_b32 v7, v91, v87, s4
    v_perm_b32 v91, v91, v87, s5
    v_mov_b32 v87, v7
    v_perm_b32 v6, v96, v92, s4
    v_perm_b32 v96, v96, v92, s5
    v_mov_b32 v92, v6
    v_perm_b32 v7, v97, v93, s4
    v_perm_b32 v97, v97, v93, s5
    v_mov_b32 v93, v7
    v_perm_b32 v6, v98, v94, s4
    v_perm_b32 v98, v98, v94, s5
    v_mov_b32 v94, v6
    v_perm_b32 v7, v99, v95, s4
    v_perm_b32 v99, v99, v95, s5
    v_mov_b32 v95, v7
    v_perm_b32 v6, v104, v100, s4
    v_perm_b32 v104, v104, v100, s5
    v_mov_b32 v100, v6
    v_perm_b32 v7, v105, v101, s4
    v_perm_b32 v105, v105, v101, s5
    v_mov_b32 v101, v7
    v_perm_b32 v6, v106, v102, s4
    v_perm_b32 v106, v106, v102, s5
    v_mov_b32 v102, v6
    v_perm_b32 v7, v107, v103, s4
    v_perm_b32 v107, v107, v103, s5
    v_mov_b32 v103, v7
    v_perm_b32 v6, v112, v108, s4
    v_perm_b32 v112, v112, v108, s5
    v_mov_b32 v108, v6
    v_perm_b32 v7, v113, v109, s4
    v_perm_b32 v113, v113, v109, s5
    v_mov_b32 v109, v7
    v_perm_b32 v6, v114, v110, s4
    v_perm_b32 v114, v114, v110, s5
    v_mov_b32 v110, v6
    v_perm_b32 v7, v115, v111, s4
    v_perm_b32 v115, v115, v111, s5
    v_mov_b32 v111, v7
    v_perm_b32 v6, v120, v116, s4
    v_perm_b32 v120, v120, v116, s5
    v_mov_b32 v116, v6
    v_perm_b32 v7, v121, v117, s4
    v_perm_b32 v121, v121, v117, s5
    v_mov_b32 v117, v7
    v_perm_b32 v6, v122, v118, s4
    v_perm_b32 v122, v122, v118, s5
    v_mov_b32 v118, v6
    v_perm_b32 v7, v123, v119, s4
    v_perm_b32 v123, v123, v119, s5
    v_mov_b32 v119, v7
    v_perm_b32 v6, v128, v124, s4
    v_perm_b32 v128, v128, v124, s5
    v_mov_b32 v124, v6
    v_perm_b32 v7, v129, v125, s4
    v_perm_b32 v129, v129, v125, s5
    v_mov_b32 v125, v7
    v_perm_b32 v6, v130, v126, s4
    v_perm_b32 v130, v130, v126, s5
    v_mov_b32 v126, v6
    v_perm_b32 v7, v131, v127, s4
    v_perm_b32 v131, v131, v127, s5
    v_mov_b32 v127, v7
    v_perm_b32 v6, v136, v132, s4
    v_perm_b32 v136, v136, v132, s5
    v_mov_b32 v132, v6
    v_perm_b32 v7, v137, v133, s4
    v_perm_b32 v137, v137, v133, s5
    v_mov_b32 v133, v7
    v_perm_b32 v6, v138, v134, s4
    v_perm_b32 v138, v138, v134, s5
    v_mov_b32 v134, v6
    v_perm_b32 v7, v139, v135, s4
    v_perm_b32 v139, v139, v135, s5
    v_mov_b32 v135, v7
    v_perm_b32 v6, v144, v140, s4
    v_perm_b32 v144, v144, v140, s5
    v_mov_b32 v140, v6
    v_perm_b32 v7, v145, v141, s4
    v_perm_b32 v145, v145, v141, s5
    v_mov_b32 v141, v7
    v_perm_b32 v6, v146, v142, s4
    v_perm_b32 v146, v146, v142, s5
    v_mov_b32 v142, v6
    v_perm_b32 v7, v147, v143, s4
    v_perm_b32 v147, v147, v143, s5
    v_mov_b32 v143, v7
    v_perm_b32 v6, v152, v148, s4
    v_perm_b32 v152, v152, v148, s5
    v_mov_b32 v148, v6
    v_perm_b32 v7, v153, v149, s4
    v_perm_b32 v153, v153, v149, s5
    v_mov_b32 v149, v7
    v_perm_b32 v6, v154, v150, s4
    v_perm_b32 v154, v154, v150, s5
    v_mov_b32 v150, v6
    v_perm_b32 v7, v155, v151, s4
    v_perm_b32 v155, v155, v151, s5
    v_mov_b32 v151, v7
    v_perm_b32 v6, v160, v156, s4
    v_perm_b32 v160, v160, v156, s5
    v_mov_b32 v156, v6
    v_perm_b32 v7, v161, v157, s4
    v_perm_b32 v161, v161, v157, s5
    v_mov_b32 v157, v7
    v_perm_b32 v6, v162, v158, s4
    v_perm_b32 v162, v162, v158, s5
    v_mov_b32 v158, v6
    v_perm_b32 v7, v163, v159, s4
    v_perm_b32 v163, v163, v159, s5
    v_mov_b32 v159, v7
    s_branch L_e_main
L_e_hi:
    v_mul_u32_u24 v2, 5120, v14
    v_lshl_add_u32 v2, v15, 4, v2
    s_sub_u32 s5, s3, 4
    s_mul_i32 s5, s5, 20480
    s_add_u32 s4, s4, s5
    s_add_u32 s4, s4, 1024
    buffer_load_dwordx4 v[100:103], v2, s[28:31], s4 offen nt
    s_add_u32 s4, s4, 1280
    buffer_load_dwordx4 v[104:107], v2, s[28:31], s4 offen nt
    s_add_u32 s4, s4, 1280
    buffer_load_dwordx4 v[108:111], v2, s[28:31], s4 offen nt
    s_add_u32 s4, s4, 1280
    buffer_load_dwordx4 v[112:115], v2, s[28:31], s4 offen nt
    s_waitcnt vmcnt(0)
    s_mov_b32 s4, 0x05040100
    s_mov_b32 s5, 0x07060302
    v_perm_b32 v6, v24, v20, s4
    v_perm_b32 v24, v24, v20, s5
    v_mov_b32 v20, v6
    v_perm_b32 v7, v25, v21, s4
    v_perm_b32 v25, v25, v21, s5
    v_mov_b32 v21, v7
    v_perm_b32 v6, v26, v22, s4
    v_perm_b32 v26, v26, v22, s5
    v_mov_b32 v22, v6
    v_perm_b32 v7, v27, v23, s4
    v_perm_b32 v27, v27, v23, s5
    v_mov_b32 v23, v7
    v_perm_b32 v6, v32, v28, s4
    v_perm_b32 v32, v32, v28, s5
    v_mov_b32 v28, v6
    v_perm_b32 v7, v33, v29, s4
    v_perm_b32 v33, v33, v29, s5
    v_mov_b32 v29, v7
    v_perm_b32 v6, v34, v30, s4
    v_perm_b32 v34, v34, v30, s5
    v_mov_b32 v30, v6
    v_perm_b32 v7, v35, v31, s4
    v_perm_b32 v35, v35, v31, s5
    v_mov_b32 v31, v7
    v_perm_b32 v6, v40, v36, s4
    v_perm_b32 v40, v40, v36, s5
    v_mov_b32 v36, v6
    v_perm_b32 v7, v41, v37, s4
    v_perm_b32 v41, v41, v37, s5
    v_mov_b32 v37, v7
    v_perm_b32 v6, v42, v38, s4
    v_perm_b32 v42, v42, v38, s5
    v_mov_b32 v38, v6
    v_perm_b32 v7, v43, v39, s4
    v_perm_b32 v43, v43, v39, s5
    v_mov_b32 v39, v7
    v_perm_b32 v6, v48, v44, s4
    v_perm_b32 v48, v48, v44, s5
    v_mov_b32 v44, v6
    v_perm_b32 v7, v49, v45, s4
    v_perm_b32 v49, v49, v45, s5
    v_mov_b32 v45, v7
    v_perm_b32 v6, v50, v46, s4
    v_perm_b32 v50, v50, v46, s5
    v_mov_b32 v46, v6
    v_perm_b32 v7, v51, v47, s4
    v_perm_b32 v51, v51, v47, s5
    v_mov_b32 v47, v7
    v_perm_b32 v6, v56, v52, s4
    v_perm_b32 v56, v56, v52, s5
    v_mov_b32 v52, v6
    v_perm_b32 v7, v57, v53, s4
    v_perm_b32 v57, v57, v53, s5
    v_mov_b32 v53, v7
    v_perm_b32 v6, v58, v54, s4
    v_perm_b32 v58, v58, v54, s5
    v_mov_b32 v54, v6
    v_perm_b32 v7, v59, v55, s4
    v_perm_b32 v59, v59, v55, s5
    v_mov_b32 v55, v7
    v_perm_b32 v6, v64, v60, s4
    v_perm_b32 v64, v64, v60, s5
    v_mov_b32 v60, v6
    v_perm_b32 v7, v65, v61, s4
    v_perm_b32 v65, v65, v61, s5
    v_mov_b32 v61, v7
    v_perm_b32 v6, v66, v62, s4
    v_perm_b32 v66, v66, v62, s5
    v_mov_b32 v62, v6
    v_perm_b32 v7, v67, v63, s4
    v_perm_b32 v67, v67, v63, s5
    v_mov_b32 v63, v7
    v_perm_b32 v6, v72, v68, s4
    v_perm_b32 v72, v72, v68, s5
    v_mov_b32 v68, v6
    v_perm_b32 v7, v73, v69, s4
    v_perm_b32 v73, v73, v69, s5
    v_mov_b32 v69, v7
    v_perm_b32 v6, v74, v70, s4
    v_perm_b32 v74, v74, v70, s5
    v_mov_b32 v70, v6
    v_perm_b32 v7, v75, v71, s4
    v_perm_b32 v75, v75, v71, s5
    v_mov_b32 v71, v7
    v_perm_b32 v6, v80, v76, s4
    v_perm_b32 v80, v80, v76, s5
    v_mov_b32 v76, v6
    v_perm_b32 v7, v81, v77, s4
    v_perm_b32 v81, v81, v77, s5
    v_mov_b32 v77, v7
    v_perm_b32 v6, v82, v78, s4
    v_perm_b32 v82, v82, v78, s5
    v_mov_b32 v78, v6
    v_perm_b32 v7, v83, v79, s4
    v_perm_b32 v83, v83, v79, s5
    v_mov_b32 v79, v7
    v_perm_b32 v6, v88, v84, s4
    v_perm_b32 v88, v88, v84, s5
    v_mov_b32 v84, v6
    v_perm_b32 v7, v89, v85, s4
    v_perm_b32 v89, v89, v85, s5
    v_mov_b32 v85, v7
    v_perm_b32 v6, v90, v86, s4
    v_perm_b32 v90, v90, v86, s5
    v_mov_b32 v86, v6
    v_perm_b32 v7, v91, v87, s4
    v_perm_b32 v91, v91, v87, s5
    v_mov_b32 v87, v7
    v_perm_b32 v6, v96, v92, s4
    v_perm_b32 v96, v96, v92, s5
    v_mov_b32 v92, v6
    v_perm_b32 v7, v97, v93, s4
    v_perm_b32 v97, v97, v93, s5
    v_mov_b32 v93, v7
    v_perm_b32 v6, v98, v94, s4
    v_perm_b32 v98, v98, v94, s5
    v_mov_b32 v94, v6
    v_perm_b32 v7, v99, v95, s4
    v_perm_b32 v99, v99, v95, s5
    v_mov_b32 v95, v7
    v_perm_b32 v6, v104, v100, s4
    v_perm_b32 v104, v104, v100, s5
    v_mov_b32 v100, v6
    v_perm_b32 v7, v105, v101, s4
    v_perm_b32 v105, v105, v101, s5
    v_mov_b32 v101, v7
    v_perm_b32 v6, v106, v102, s4
    v_perm_b32 v106, v106, v102, s5
    v_mov_b32 v102, v6
    v_perm_b32 v7, v107, v103, s4
    v_perm_b32 v107, v107, v103, s5
    v_mov_b32 v103, v7
    v_perm_b32 v6, v112, v108, s4
    v_perm_b32 v112, v112, v108, s5
    v_mov_b32 v108, v6
    v_perm_b32 v7, v113, v109, s4
    v_perm_b32 v113, v113, v109, s5
    v_mov_b32 v109, v7
    v_perm_b32 v6, v114, v110, s4
    v_perm_b32 v114, v114, v110, s5
    v_mov_b32 v110, v6
    v_perm_b32 v7, v115, v111, s4
    v_perm_b32 v115, v115, v111, s5
    v_mov_b32 v111, v7
L_e_main:
    s_cmp_lg_u32 s3, 0
    s_cselect_b32 s99, s100, 0
    s_cmp_lg_u32 s99, 0
    s_cbranch_scc1 L_nofw_61
    v_lshlrev_b32 v2, 4, v1
    v_add_u32 v2, 2048, v2
    s_cbranch_execz L_spin_62_x
    s_mov_b32 s98, 0
L_spin_62:
    buffer_load_dwordx4 v[4:7], v2, s[8:11], 0 offen sc1
    buffer_load_dwordx4 v[8:11], v2, s[8:11], 0 offen offset:1024 sc1
    s_waitcnt vmcnt(0)
    v_xor_b32 v4, s96, v4
    v_xor_b32 v5, s97, v5
    v_xor_b32 v6, s96, v6
    v_xor_b32 v7, s97, v7
    v_xor_b32 v8, s96, v8
    v_xor_b32 v9, s97, v9
    v_xor_b32 v10, s96, v10
    v_xor_b32 v11, s97, v11
    v_or3_b32 v4, v4, v5, v6
    v_or3_b32 v4, v4, v7, v8
    v_or3_b32 v4, v4, v9, v10
    v_or_b32 v4, v4, v11
    v_cmp_ne_u32 vcc, 0, v4
    s_cbranch_vccz L_spd_63
    s_add_u32 s98, s98, 1
    s_cmp_gt_u32 s98, 200000
    s_cbranch_scc1 L_end
    s_sleep 1
    s_branch L_spin_62
L_spd_63:
L_spin_62_x:
L_nofw_61:
    s_cmp_eq_u32 s100, 0
    s_cbranch_scc1 L_bar_64
    s_barrier
L_bar_64:
    v_and_b32 v2, 1, v14
    v_lshlrev_b32 v2, 2, v2
    v_lshl_add_u32 v2, v15, 3, v2
    s_lshl_b32 s4, s3, 7
    v_add_u32 v12, s4, v2
    s_cmp_gt_u32 s3, 4
    s_cselect_b32 s99, s100, 0
    s_cmp_lg_u32 s99, 0
    s_cbranch_scc1 L_w5_65
    v_lshlrev_b32 v2, 1, v12
    s_mul_i32 s4, s43, 1280
    buffer_load_dwordx2 v[4:5], v2, s[32:35], s4 offen
    v_lshlrev_b32 v2, 2, v12
    s_mul_i32 s4, s43, 15360
    s_add_u32 s48, s4, 13312
    s_add_u32 s49, s48, 2560
    s_add_u32 s50, s48, 5120
    s_add_u32 s51, s48, 30720
    s_add_u32 s52, s48, 33280
    s_add_u32 s53, s48, 35840
    s_add_u32 s54, s48, 61440
    s_add_u32 s55, s48, 64000
    s_add_u32 s56, s48, 66560
    s_add_u32 s57, s48, 92160
    s_add_u32 s58, s48, 94720
    s_add_u32 s59, s48, 97280
    s_cbranch_execz L_spin_66_x
    s_mov_b32 s98, 0
L_spin_66:
    buffer_load_dwordx4 v[164:167], v2, s[8:11], s48 offen sc1
    buffer_load_dwordx4 v[168:171], v2, s[8:11], s49 offen sc1
    buffer_load_dwordx4 v[172:175], v2, s[8:11], s50 offen sc1
    buffer_load_dwordx4 v[176:179], v2, s[8:11], s51 offen sc1
    buffer_load_dwordx4 v[180:183], v2, s[8:11], s52 offen sc1
    buffer_load_dwordx4 v[184:187], v2, s[8:11], s53 offen sc1
    buffer_load_dwordx4 v[188:191], v2, s[8:11], s54 offen sc1
    buffer_load_dwordx4 v[192:195], v2, s[8:11], s55 offen sc1
    buffer_load_dwordx4 v[196:199], v2, s[8:11], s56 offen sc1
    buffer_load_dwordx4 v[200:203], v2, s[8:11], s57 offen sc1
    buffer_load_dwordx4 v[204:207], v2, s[8:11], s58 offen sc1
    buffer_load_dwordx4 v[208:211], v2, s[8:11], s59 offen sc1
    s_waitcnt vmcnt(0)
    v_max3_u32 v6, v164, v165, v166
    v_max3_u32 v6, v6, v167, v168
    v_max3_u32 v6, v6, v169, v170
    v_max3_u32 v6, v6, v171, v172
    v_max3_u32 v6, v6, v173, v174
    v_max3_u32 v6, v6, v175, v176
    v_max3_u32 v6, v6, v177, v178
    v_max3_u32 v6, v6, v179, v180
    v_max3_u32 v6, v6, v181, v182
    v_max3_u32 v6, v6, v183, v184
    v_max3_u32 v6, v6, v185, v186
    v_max3_u32 v6, v6, v187, v188
    v_max3_u32 v6, v6, v189, v190
    v_max3_u32 v6, v6, v191, v192
    v_max3_u32 v6, v6, v193, v194
    v_max3_u32 v6, v6, v195, v196
    v_max3_u32 v6, v6, v197, v198
    v_max3_u32 v6, v6, v199, v200
    v_max3_u32 v6, v6, v201, v202
    v_max3_u32 v6, v6, v203, v204
    v_max3_u32 v6, v6, v205, v206
    v_max3_u32 v6, v6, v207, v208
    v_max3_u32 v6, v6, v209, v210
    v_max_u32 v6, v6, v211
    v_cmp_eq_u32 vcc, -1, v6
    s_cbranch_vccz L_spd_67
    s_add_u32 s98, s98, 1
    s_cmp_gt_u32 s98, 200000
    s_cbranch_scc1 L_end
    s_sleep 1
    s_branch L_spin_66
L_spd_67:
L_spin_66_x:
    v_add_f32 v164, v164, v176
    v_add_f32 v188, v188, v200
    v_add_f32 v164, v164, v188
    v_cvt_pk_bf16_f32 v164, v164, v164
    v_and_b32 v164, 0xffff0000, v164
    v_add_f32 v165, v165, v177
    v_add_f32 v189, v189, v201
    v_add_f32 v165, v165, v189
    v_cvt_pk_bf16_f32 v165, v165, v165
    v_and_b32 v165, 0xffff0000, v165
    v_add_f32 v166, v166, v178
    v_add_f32 v190, v190, v202
    v_add_f32 v166, v166, v190
    v_cvt_pk_bf16_f32 v166, v166, v166
    v_and_b32 v166, 0xffff0000, v166
    v_add_f32 v167, v167, v179
    v_add_f32 v191, v191, v203
    v_add_f32 v167, v167, v191
    v_cvt_pk_bf16_f32 v167, v167, v167
    v_and_b32 v167, 0xffff0000, v167
    v_add_f32 v168, v168, v180
    v_add_f32 v192, v192, v204
    v_add_f32 v168, v168, v192
    v_cvt_pk_bf16_f32 v168, v168, v168
    v_and_b32 v168, 0xffff0000, v168
    v_add_f32 v169, v169, v181
    v_add_f32 v193, v193, v205
    v_add_f32 v169, v169, v193
    v_cvt_pk_bf16_f32 v169, v169, v169
    v_and_b32 v169, 0xffff0000, v169
    v_add_f32 v170, v170, v182
    v_add_f32 v194, v194, v206
    v_add_f32 v170, v170, v194
    v_cvt_pk_bf16_f32 v170, v170, v170
    v_and_b32 v170, 0xffff0000, v170
    v_add_f32 v171, v171, v183
    v_add_f32 v195, v195, v207
    v_add_f32 v171, v171, v195
    v_cvt_pk_bf16_f32 v171, v171, v171
    v_and_b32 v171, 0xffff0000, v171
    v_add_f32 v172, v172, v184
    v_add_f32 v196, v196, v208
    v_add_f32 v172, v172, v196
    v_cvt_pk_bf16_f32 v172, v172, v172
    v_and_b32 v172, 0xffff0000, v172
    v_add_f32 v173, v173, v185
    v_add_f32 v197, v197, v209
    v_add_f32 v173, v173, v197
    v_cvt_pk_bf16_f32 v173, v173, v173
    v_and_b32 v173, 0xffff0000, v173
    v_add_f32 v174, v174, v186
    v_add_f32 v198, v198, v210
    v_add_f32 v174, v174, v198
    v_cvt_pk_bf16_f32 v174, v174, v174
    v_and_b32 v174, 0xffff0000, v174
    v_add_f32 v175, v175, v187
    v_add_f32 v199, v199, v211
    v_add_f32 v175, v175, v199
    v_cvt_pk_bf16_f32 v175, v175, v175
    v_and_b32 v175, 0xffff0000, v175
    v_lshlrev_b32 v176, 16, v4
    v_and_b32 v177, 0xffff0000, v4
    v_lshlrev_b32 v178, 16, v5
    v_and_b32 v179, 0xffff0000, v5
    v_add_f32 v172, 1.0, v172
    v_cvt_pk_bf16_f32 v172, v172, v172
    v_and_b32 v172, 0xffff0000, v172
    v_add_f32 v173, 1.0, v173
    v_cvt_pk_bf16_f32 v173, v173, v173
    v_and_b32 v173, 0xffff0000, v173
    v_add_f32 v174, 1.0, v174
    v_cvt_pk_bf16_f32 v174, v174, v174
    v_and_b32 v174, 0xffff0000, v174
    v_add_f32 v175, 1.0, v175
    v_cvt_pk_bf16_f32 v175, v175, v175
    v_and_b32 v175, 0xffff0000, v175
    v_and_b32 v204, 0x3f803f80, v16
    v_and_b32 v205, 0x3f803f80, v17
    v_and_b32 v206, 0x3f803f80, v18
    v_and_b32 v207, 0x3f803f80, v19
    v_mul_u32_u24 v3, 10240, v14
    v_lshl_add_u32 v3, v15, 4, v3
    s_mul_i32 s4, s43, 40960
    s_lshl_b32 s5, s3, 8
    s_add_u32 s4, s4, s5
    s_add_u32 s4, s4, 360448
    s_add_u32 s5, s4, 3840
    s_add_u32 s6, s4, 7680
L_w5_65:
    s_cmp_lg_u32 s3, 5
    s_cselect_b32 s99, s100, 0
    s_cmp_lg_u32 s99, 0
    s_cbranch_scc1 L_nolp_68
    v_and_b32 v2, 31, v1
    v_mul_u32_u24 v2, 1280, v2
    s_mul_i32 s4, s43, 40960
    s_add_u32 s4, s4, 360700
    s_cbranch_execz L_lpd_70
    s_mov_b32 s98, 0
    buffer_load_dword v4, v2, s[8:11], s4 offen sc1
    s_sleep 5
    buffer_load_dword v5, v2, s[8:11], s4 offen sc1
    s_sleep 5
L_lp_69:
    buffer_load_dword v6, v2, s[8:11], s4 offen sc1
    s_waitcnt vmcnt(2)
    v_cmp_eq_u32 vcc, -1, v4
    s_bcnt1_i32_b64 s99, vcc
    s_cmp_le_u32 s99, 24
    s_cbranch_scc1 L_lpd_70
    buffer_load_dword v4, v2, s[8:11], s4 offen sc1
    s_waitcnt vmcnt(2)
    v_cmp_eq_u32 vcc, -1, v5
    s_bcnt1_i32_b64 s99, vcc
    s_cmp_le_u32 s99, 24
    s_cbranch_scc1 L_lpd_70
    buffer_load_dword v5, v2, s[8:11], s4 offen sc1
    s_waitcnt vmcnt(2)
    v_cmp_eq_u32 vcc, -1, v6
    s_bcnt1_i32_b64 s99, vcc
    s_cmp_le_u32 s99, 24
    s_cbranch_scc1 L_lpd_70
    s_add_u32 s98, s98, 1
    s_cmp_gt_u32 s98, 200000
    s_cbranch_scc1 L_end
    s_branch L_lp_69
L_lpd_70:
L_nolp_68:
    s_cmp_eq_u32 s100, 0
    s_cbranch_scc1 L_bar_71
    s_barrier
L_bar_71:
    s_cmp_gt_u32 s3, 4
    s_cselect_b32 s99, s100, 0
    s_cmp_lg_u32 s99, 0
    s_cbranch_scc1 L_w5a_72
    s_cbranch_execz L_spin_73_x
    s_mov_b32 s98, 0
L_spin_73:
    buffer_load_dwordx4 v[208:211], v3, s[8:11], s4 offen offset:0 sc1
    buffer_load_dwordx4 v[212:215], v3, s[8:11], s4 offen offset:1280 sc1
    buffer_load_dwordx4 v[216:219], v3, s[8:11], s4 offen offset:2560 sc1
    buffer_load_dwordx4 v[220:223], v3, s[8:11], s5 offen offset:0 sc1
    buffer_load_dwordx4 v[224:227], v3, s[8:11], s5 offen offset:1280 sc1
    buffer_load_dwordx4 v[228:231], v3, s[8:11], s5 offen offset:2560 sc1
    buffer_load_dwordx4 v[232:235], v3, s[8:11], s6 offen offset:0 sc1
    buffer_load_dwordx4 v[236:239], v3, s[8:11], s6 offen offset:1280 sc1
    s_waitcnt vmcnt(0)
    v_max3_u32 v6, v208, v209, v210
    v_max3_u32 v6, v6, v211, v212
    v_max3_u32 v6, v6, v213, v214
    v_max3_u32 v6, v6, v215, v216
    v_max3_u32 v6, v6, v217, v218
    v_max3_u32 v6, v6, v219, v220
    v_max3_u32 v6, v6, v221, v222
    v_max3_u32 v6, v6, v223, v224
    v_max3_u32 v6, v6, v225, v226
    v_max3_u32 v6, v6, v227, v228
    v_max3_u32 v6, v6, v229, v230
    v_max3_u32 v6, v6, v231, v232
    v_max3_u32 v6, v6, v233, v234
    v_max3_u32 v6, v6, v235, v236
    v_max3_u32 v6, v6, v237, v238
    v_max_u32 v6, v6, v239
    v_cmp_eq_u32 vcc, -1, v6
    s_cbranch_vccz L_spd_74
    s_add_u32 s98, s98, 1
    s_cmp_gt_u32 s98, 200000
    s_cbranch_scc1 L_end
    s_sleep 1
    s_branch L_spin_73
L_spd_74:
L_spin_73_x:
    v_mfma_f32_16x16x32_bf16 v[180:183], v[204:207], v[208:211], 0
    v_mfma_f32_16x16x32_bf16 v[180:183], v[204:207], v[212:215], v[180:183]
    v_mfma_f32_16x16x32_bf16 v[180:183], v[204:207], v[216:219], v[180:183]
    v_mfma_f32_16x16x32_bf16 v[180:183], v[204:207], v[220:223], v[180:183]
    v_mfma_f32_16x16x32_bf16 v[180:183], v[204:207], v[224:227], v[180:183]
    v_mfma_f32_16x16x32_bf16 v[180:183], v[204:207], v[228:231], v[180:183]
    v_mfma_f32_16x16x32_bf16 v[180:183], v[204:207], v[232:235], v[180:183]
    v_mfma_f32_16x16x32_bf16 v[180:183], v[204:207], v[236:239], v[180:183]
    s_nop 8
    v_cvt_pk_bf16_f32 v180, v180, v180
    v_and_b32 v180, 0xffff0000, v180
    v_mul_f32 v180, v164, v180
    v_cvt_pk_bf16_f32 v180, v180, v180
    v_and_b32 v180, 0xffff0000, v180
    v_add_f32 v180, v176, v180
    v_cvt_pk_bf16_f32 v180, v180, v180
    v_and_b32 v180, 0xffff0000, v180
    v_cvt_pk_bf16_f32 v181, v181, v181
    v_and_b32 v181, 0xffff0000, v181
    v_mul_f32 v181, v165, v181
    v_cvt_pk_bf16_f32 v181, v181, v181
    v_and_b32 v181, 0xffff0000, v181
    v_add_f32 v181, v177, v181
    v_cvt_pk_bf16_f32 v181, v181, v181
    v_and_b32 v181, 0xffff0000, v181
    v_cvt_pk_bf16_f32 v182, v182, v182
    v_and_b32 v182, 0xffff0000, v182
    v_mul_f32 v182, v166, v182
    v_cvt_pk_bf16_f32 v182, v182, v182
    v_and_b32 v182, 0xffff0000, v182
    v_add_f32 v182, v178, v182
    v_cvt_pk_bf16_f32 v182, v182, v182
    v_and_b32 v182, 0xffff0000, v182
    v_cvt_pk_bf16_f32 v183, v183, v183
    v_and_b32 v183, 0xffff0000, v183
    v_mul_f32 v183, v167, v183
    v_cvt_pk_bf16_f32 v183, v183, v183
    v_and_b32 v183, 0xffff0000, v183
    v_add_f32 v183, v179, v183
    v_cvt_pk_bf16_f32 v183, v183, v183
    v_and_b32 v183, 0xffff0000, v183
    v_cmp_gt_u32 vcc, 32, v1
    v_add_f32 v6, v180, v181
    v_add_f32 v7, v182, v183
    v_add_f32 v6, v6, v7
    v_cndmask_b32 v6, 0, v6, vcc
    s_nop 1
    v_add_f32_dpp v6, v6, v6 quad_perm:[1,0,3,2] row_mask:0xf bank_mask:0xf
    s_nop 1
    v_add_f32_dpp v6, v6, v6 quad_perm:[2,3,0,1] row_mask:0xf bank_mask:0xf
    s_nop 1
    v_add_f32_dpp v6, v6, v6 row_half_mirror row_mask:0xf bank_mask:0xf
    s_nop 1
    v_add_f32_dpp v6, v6, v6 row_mirror row_mask:0xf bank_mask:0xf
    v_mov_b32 v7, v6
    s_nop 1
    v_permlane16_swap_b32 v6, v7
    s_nop 0
    v_add_f32 v6, v6, v7
    v_mov_b32 v7, v6
    s_nop 1
    v_permlane32_swap_b32 v6, v7
    s_nop 0
    v_add_f32 v6, v6, v7
    v_mul_f32 v6, 0x3c000000, v6
    v_sub_f32 v184, v180, v6
    v_sub_f32 v185, v181, v6
    v_sub_f32 v186, v182, v6
    v_sub_f32 v187, v183, v6
    v_mul_f32 v8, v184, v184
    v_fmac_f32 v8, v185, v185
    v_fmac_f32 v8, v186, v186
    v_fmac_f32 v8, v187, v187
    v_cndmask_b32 v8, 0, v8, vcc
    s_nop 1
    v_add_f32_dpp v8, v8, v8 quad_perm:[1,0,3,2] row_mask:0xf bank_mask:0xf
    s_nop 1
    v_add_f32_dpp v8, v8, v8 quad_perm:[2,3,0,1] row_mask:0xf bank_mask:0xf
    s_nop 1
    v_add_f32_dpp v8, v8, v8 row_half_mirror row_mask:0xf bank_mask:0xf
    s_nop 1
    v_add_f32_dpp v8, v8, v8 row_mirror row_mask:0xf bank_mask:0xf
    v_mov_b32 v7, v8
    s_nop 1
    v_permlane16_swap_b32 v8, v7
    s_nop 0
    v_add_f32 v8, v8, v7
    v_mov_b32 v7, v8
    s_nop 1
    v_permlane32_swap_b32 v8, v7
    s_nop 0
    v_add_f32 v8, v8, v7
    v_mov_b32 v7, v8
    s_lshl_b32 s4, s3, 3
    s_add_u32 s4, s4, 45056
    v_mov_b32 v2, s4
    v_lshlrev_b32 v3, 2, v12
    v_add_u32 v3, 45312, v3
    s_and_b32 exec_lo, s100, 0x1
    s_mov_b32 exec_hi, 0
    ds_write_b64 v2, v[6:7]
    s_and_b32 exec_lo, s100, 0xffffffff
    s_mov_b32 exec_hi, 0
    ds_write_b128 v3, v[180:183]
    s_mov_b64 exec, s[100:101]
    s_waitcnt lgkmcnt(0)
L_w5a_72:
    s_cmp_eq_u32 s100, 0
    s_cbranch_scc1 L_bar_75
    s_barrier
L_bar_75:
    s_cmp_gt_u32 s3, 4
    s_cselect_b32 s99, s100, 0
    s_cmp_lg_u32 s99, 0
    s_cbranch_scc1 L_w5b_76
    v_mov_b32 v2, 45056
    ds_read_b128 v[184:187], v2
    ds_read_b128 v[188:191], v2 offset:16
    ds_read_b64 v[192:193], v2 offset:32
    s_waitcnt lgkmcnt(0)
    v_add_f32 v6, v184, v186
    v_add_f32 v6, v6, v188
    v_add_f32 v6, v6, v190
    v_add_f32 v6, v6, v192
    v_mul_f32 v6, 0x3e4ccccd, v6
    v_add_f32 v7, v185, v187
    v_add_f32 v7, v7, v189
    v_add_f32 v7, v7, v191
    v_add_f32 v7, v7, v193
    v_sub_f32 v8, v184, v6
    v_mul_f32 v8, v8, v8
    v_fmac_f32 v7, 0x43000000, v8
    v_sub_f32 v8, v186, v6
    v_mul_f32 v8, v8, v8
    v_fmac_f32 v7, 0x43000000, v8
    v_sub_f32 v8, v188, v6
    v_mul_f32 v8, v8, v8
    v_fmac_f32 v7, 0x43000000, v8
    v_sub_f32 v8, v190, v6
    v_mul_f32 v8, v8, v8
    v_fmac_f32 v7, 0x43000000, v8
    v_sub_f32 v8, v192, v6
    v_mul_f32 v8, v8, v8
    v_fmac_f32 v7, 0x43000000, v8
    v_mul_f32 v7, 0x3acccccd, v7
    v_cvt_pk_bf16_f32 v6, v6, v6
    v_and_b32 v6, 0xffff0000, v6
    v_cvt_pk_bf16_f32 v7, v7, v7
    v_and_b32 v7, 0xffff0000, v7
    v_add_f32 v7, 0x3727c5ac, v7
    v_cvt_pk_bf16_f32 v7, v7, v7
    v_and_b32 v7, 0xffff0000, v7
    v_sqrt_f32 v7, v7
    s_nop 0
    v_cvt_pk_bf16_f32 v7, v7, v7
    v_and_b32 v7, 0xffff0000, v7
    v_rcp_f32 v7, v7
    v_sub_f32 v184, v180, v6
    v_cvt_pk_bf16_f32 v184, v184, v184
    v_and_b32 v184, 0xffff0000, v184
    v_mul_f32 v184, v184, v7
    v_cvt_pk_bf16_f32 v184, v184, v184
    v_and_b32 v184, 0xffff0000, v184
    v_mul_f32 v184, v184, v172
    v_cvt_pk_bf16_f32 v184, v184, v184
    v_and_b32 v184, 0xffff0000, v184
    v_add_f32 v184, v184, v168
    v_sub_f32 v185, v181, v6
    v_cvt_pk_bf16_f32 v185, v185, v185
    v_and_b32 v185, 0xffff0000, v185
    v_mul_f32 v185, v185, v7
    v_cvt_pk_bf16_f32 v185, v185, v185
    v_and_b32 v185, 0xffff0000, v185
    v_mul_f32 v185, v185, v173
    v_cvt_pk_bf16_f32 v185, v185, v185
    v_and_b32 v185, 0xffff0000, v185
    v_add_f32 v185, v185, v169
    v_sub_f32 v186, v182, v6
    v_cvt_pk_bf16_f32 v186, v186, v186
    v_and_b32 v186, 0xffff0000, v186
    v_mul_f32 v186, v186, v7
    v_cvt_pk_bf16_f32 v186, v186, v186
    v_and_b32 v186, 0xffff0000, v186
    v_mul_f32 v186, v186, v174
    v_cvt_pk_bf16_f32 v186, v186, v186
    v_and_b32 v186, 0xffff0000, v186
    v_add_f32 v186, v186, v170
    v_sub_f32 v187, v183, v6
    v_cvt_pk_bf16_f32 v187, v187, v187
    v_and_b32 v187, 0xffff0000, v187
    v_mul_f32 v187, v187, v7
    v_cvt_pk_bf16_f32 v187, v187, v187
    v_and_b32 v187, 0xffff0000, v187
    v_mul_f32 v187, v187, v175
    v_cvt_pk_bf16_f32 v187, v187, v187
    v_and_b32 v187, 0xffff0000, v187
    v_add_f32 v187, v187, v171
    v_cvt_pk_bf16_f32 v184, v184, v185
    v_cvt_pk_bf16_f32 v185, v186, v187
    v_lshlrev_b32 v3, 1, v12
    v_add_u32 v3, 48128, v3
    s_and_b32 exec_lo, s100, 0xffffffff
    s_mov_b32 exec_hi, 0
    ds_write_b64 v3, v[184:185]
    s_mov_b64 exec, s[100:101]
    s_waitcnt lgkmcnt(0)
L_w5b_76:
    s_cmp_eq_u32 s100, 0
    s_cbranch_scc1 L_bar_77
    s_barrier
L_bar_77:
    v_mul_u32_u24 v2, 40, v14
    s_mul_i32 s4, s3, 160
    s_add_u32 s4, s4, 48128
    v_add_u32 v2, s4, v2
    ds_read_b64 v[164:165], v2 offset:0
    ds_read_b64 v[166:167], v2 offset:8
    ds_read_b64 v[168:169], v2 offset:16
    ds_read_b64 v[170:171], v2 offset:24
    ds_read_b64 v[172:173], v2 offset:32
    s_lshl_b32 s4, s3, 9
    s_add_u32 s4, s4, 53248
    v_add_u32 v3, s4, v13
    s_waitcnt lgkmcnt(0)
    v_and_b32 v204, v240, v164
    v_and_b32 v205, v241, v164
    v_and_b32 v206, v242, v164
    v_and_b32 v207, v243, v164
    v_and_b32 v208, v240, v165
    v_and_b32 v209, v241, v165
    v_and_b32 v210, v242, v165
    v_and_b32 v211, v243, v165
    v_mfma_f32_16x16x32_bf16 v[212:215], v[204:207], v[20:23], 0
    v_mfma_f32_16x16x32_bf16 v[216:219], v[204:207], v[24:27], 0
    v_and_b32 v204, v240, v166
    v_and_b32 v205, v241, v166
    v_and_b32 v206, v242, v166
    v_and_b32 v207, v243, v166
    v_mfma_f32_16x16x32_bf16 v[212:215], v[208:211], v[28:31], v[212:215]
    v_mfma_f32_16x16x32_bf16 v[216:219], v[208:211], v[32:35], v[216:219]
    v_and_b32 v208, v240, v167
    v_and_b32 v209, v241, v167
    v_and_b32 v210, v242, v167
    v_and_b32 v211, v243, v167
    v_mfma_f32_16x16x32_bf16 v[212:215], v[204:207], v[36:39], v[212:215]
    v_mfma_f32_16x16x32_bf16 v[216:219], v[204:207], v[40:43], v[216:219]
    v_and_b32 v204, v240, v168
    v_and_b32 v205, v241, v168
    v_and_b32 v206, v242, v168
    v_and_b32 v207, v243, v168
    v_mfma_f32_16x16x32_bf16 v[212:215], v[208:211], v[44:47], v[212:215]
    v_mfma_f32_16x16x32_bf16 v[216:219], v[208:211], v[48:51], v[216:219]
    v_and_b32 v208, v240, v169
    v_and_b32 v209, v241, v169
    v_and_b32 v210, v242, v169
    v_and_b32 v211, v243, v169
    v_mfma_f32_16x16x32_bf16 v[212:215], v[204:207], v[52:55], v[212:215]
    v_mfma_f32_16x16x32_bf16 v[216:219], v[204:207], v[56:59], v[216:219]
    v_and_b32 v204, v240, v170
    v_and_b32 v205, v241, v170
    v_and_b32 v206, v242, v170
    v_and_b32 v207, v243, v170
    v_mfma_f32_16x16x32_bf16 v[212:215], v[208:211], v[60:63], v[212:215]
    v_mfma_f32_16x16x32_bf16 v[216:219], v[208:211], v[64:67], v[216:219]
    v_and_b32 v208, v240, v171
    v_and_b32 v209, v241, v171
    v_and_b32 v210, v242, v171
    v_and_b32 v211, v243, v171
    v_mfma_f32_16x16x32_bf16 v[212:215], v[204:207], v[68:71], v[212:215]
    v_mfma_f32_16x16x32_bf16 v[216:219], v[204:207], v[72:75], v[216:219]
    v_and_b32 v204, v240, v172
    v_and_b32 v205, v241, v172
    v_and_b32 v206, v242, v172
    v_and_b32 v207, v243, v172
    v_mfma_f32_16x16x32_bf16 v[212:215], v[208:211], v[76:79], v[212:215]
    v_mfma_f32_16x16x32_bf16 v[216:219], v[208:211], v[80:83], v[216:219]
    v_and_b32 v208, v240, v173
    v_and_b32 v209, v241, v173
    v_and_b32 v210, v242, v173
    v_and_b32 v211, v243, v173
    v_mfma_f32_16x16x32_bf16 v[212:215], v[204:207], v[84:87], v[212:215]
    v_mfma_f32_16x16x32_bf16 v[216:219], v[204:207], v[88:91], v[216:219]
    s_nop 1
    v_mfma_f32_16x16x32_bf16 v[212:215], v[208:211], v[92:95], v[212:215]
    v_mfma_f32_16x16x32_bf16 v[216:219], v[208:211], v[96:99], v[216:219]
    s_nop 8
    s_and_b32 exec_lo, s100, 0xffff
    s_mov_b32 exec_hi, 0
    ds_write_b128 v3, v[212:215]
    ds_write_b128 v3, v[216:219] offset:256
    s_mov_b64 exec, s[100:101]
    s_waitcnt lgkmcnt(0)
    s_cmp_eq_u32 s100, 0
    s_cbranch_scc1 L_bar_78
    s_barrier
L_bar_78:
    s_cmp_lg_u32 s3, 0
    s_cselect_b32 s99, s100, 0
    s_cmp_lg_u32 s99, 0
    s_cbranch_scc1 L_nohh_79
    v_lshrrev_b32 v2, 5, v1
    v_and_b32 v3, 31, v1
    v_lshlrev_b32 v3, 2, v3
    v_lshl_add_u32 v3, v2, 8, v3
    v_add_u32 v3, 53248, v3
    ds_read2_b32 v[164:165], v3 offset0:0 offset1:32
    ds_read2_b32 v[166:167], v3 offset0:128 offset1:160
    v_add_u32 v5, 1024, v3
    ds_read2_b32 v[168:169], v5 offset0:0 offset1:32
    ds_read2_b32 v[170:171], v5 offset0:128 offset1:160
    v_add_u32 v6, 2048, v3
    ds_read2_b32 v[172:173], v6 offset0:0 offset1:32
    ds_read2_b32 v[174:175], v6 offset0:128 offset1:160
    v_add_u32 v7, 3072, v3
    ds_read2_b32 v[176:177], v7 offset0:0 offset1:32
    ds_read2_b32 v[178:179], v7 offset0:128 offset1:160
    v_and_b32 v3, 31, v1
    v_lshlrev_b32 v3, 2, v3
    v_lshl_add_u32 v3, v2, 1, v3
    v_add_u32 v3, 57344, v3
    s_waitcnt lgkmcnt(0)
    v_pk_add_f32 v[164:165], v[164:165], v[166:167]
    v_pk_add_f32 v[168:169], v[168:169], v[170:171]
    v_pk_add_f32 v[172:173], v[172:173], v[174:175]
    v_pk_add_f32 v[176:177], v[176:177], v[178:179]
    v_pk_add_f32 v[164:165], v[164:165], v[168:169]
    v_pk_add_f32 v[172:173], v[172:173], v[176:177]
    v_pk_add_f32 v[164:165], v[164:165], v[172:173]
    v_cvt_pk_bf16_f32 v166, v164, v165
    v_lshlrev_b32 v164, 16, v166
    v_and_b32 v165, 0xffff0000, v166
    v_mul_f32 v164, 0xbfb8aa3b, v164
    v_exp_f32 v164, v164
    s_nop 0
    v_add_f32 v164, 1.0, v164
    v_rcp_f32 v164, v164
    s_nop 0
    v_cvt_pk_bf16_f32 v164, v164, v164
    v_and_b32 v164, 0xffff0000, v164
    v_mul_f32 v164, v164, v165
    v_cvt_pk_bf16_f32 v164, v164, v164
    ds_write_b16 v3, v164
    s_waitcnt lgkmcnt(0)
L_nohh_79:
    s_mul_i32 s4, s43, 27
    s_add_u32 s4, s4, s42
    s_mul_i32 s4, s4, 2560
    s_add_u32 s4, s4, 442368
    s_cmp_eq_u32 s100, 0
    s_cbranch_scc1 L_bar_80
    s_barrier
L_bar_80:
    s_cmp_gt_u32 s3, 3
    s_cbranch_scc1 L_e_hi2
    v_lshlrev_b32 v2, 5, v14
    v_add_u32 v2, 57344, v2
    ds_read_b128 v[164:167], v2 offset:0
    ds_read_b128 v[168:171], v2 offset:16
    s_lshl_b32 s5, s3, 9
    s_add_u32 s4, s4, s5
    s_waitcnt lgkmcnt(0)
    v_and_b32 v204, v240, v164
    v_and_b32 v205, v241, v164
    v_and_b32 v206, v242, v164
    v_and_b32 v207, v243, v164
    v_and_b32 v208, v240, v165
    v_and_b32 v209, v241, v165
    v_and_b32 v210, v242, v165
    v_and_b32 v211, v243, v165
    v_mfma_f32_16x16x32_bf16 v[212:215], v[204:207], v[100:103], 0
    v_mfma_f32_16x16x32_bf16 v[216:219], v[204:207], v[104:107], 0
    v_and_b32 v204, v240, v166
    v_and_b32 v205, v241, v166
    v_and_b32 v206, v242, v166
    v_and_b32 v207, v243, v166
    v_mfma_f32_16x16x32_bf16 v[212:215], v[208:211], v[108:111], v[212:215]
    v_mfma_f32_16x16x32_bf16 v[216:219], v[208:211], v[112:115], v[216:219]
    v_and_b32 v208, v240, v167
    v_and_b32 v209, v241, v167
    v_and_b32 v210, v242, v167
    v_and_b32 v211, v243, v167
    v_mfma_f32_16x16x32_bf16 v[212:215], v[204:207], v[116:119], v[212:215]
    v_mfma_f32_16x16x32_bf16 v[216:219], v[204:207], v[120:123], v[216:219]
    v_and_b32 v204, v240, v168
    v_and_b32 v205, v241, v168
    v_and_b32 v206, v242, v168
    v_and_b32 v207, v243, v168
    v_mfma_f32_16x16x32_bf16 v[212:215], v[208:211], v[124:127], v[212:215]
    v_mfma_f32_16x16x32_bf16 v[216:219], v[208:211], v[128:131], v[216:219]
    v_and_b32 v208, v240, v169
    v_and_b32 v209, v241, v169
    v_and_b32 v210, v242, v169
    v_and_b32 v211, v243, v169
    v_mfma_f32_16x16x32_bf16 v[212:215], v[204:207], v[132:135], v[212:215]
    v_mfma_f32_16x16x32_bf16 v[216:219], v[204:207], v[136:139], v[216:219]
    v_and_b32 v204, v240, v170
    v_and_b32 v205, v241, v170
    v_and_b32 v206, v242, v170
    v_and_b32 v207, v243, v170
    v_mfma_f32_16x16x32_bf16 v[212:215], v[208:211], v[140:143], v[212:215]
    v_mfma_f32_16x16x32_bf16 v[216:219], v[208:211], v[144:147], v[216:219]
    v_and_b32 v208, v240, v171
    v_and_b32 v209, v241, v171
    v_and_b32 v210, v242, v171
    v_and_b32 v211, v243, v171
    v_mfma_f32_16x16x32_bf16 v[212:215], v[204:207], v[148:151], v[212:215]
    v_mfma_f32_16x16x32_bf16 v[216:219], v[204:207], v[152:155], v[216:219]
    s_nop 1
    v_mfma_f32_16x16x32_bf16 v[212:215], v[208:211], v[156:159], v[212:215]
    v_mfma_f32_16x16x32_bf16 v[216:219], v[208:211], v[160:163], v[216:219]
    s_nop 8
    v_min_u32 v212, 0xfffffffe, v212
    v_min_u32 v213, 0xfffffffe, v213
    v_min_u32 v214, 0xfffffffe, v214
    v_min_u32 v215, 0xfffffffe, v215
    v_min_u32 v216, 0xfffffffe, v216
    v_min_u32 v217, 0xfffffffe, v217
    v_min_u32 v218, 0xfffffffe, v218
    v_min_u32 v219, 0xfffffffe, v219
    s_and_b32 exec_lo, s100, 0xffff
    s_mov_b32 exec_hi, 0
    buffer_store_dwordx4 v[212:215], v13, s[8:11], s4 offen sc1
    buffer_store_dwordx4 v[216:219], v13, s[8:11], s4 offen offset:256 sc1
    s_mov_b64 exec, s[100:101]
    s_cmp_eq_u32 s100, 0
    s_cbranch_scc1 L_bar_81
    s_barrier
L_bar_81:
    s_branch L_end
L_e_hi2:
    s_sub_u32 s46, s3, 4
    v_lshlrev_b32 v2, 3, v14
    s_lshl_b32 s5, s46, 5
    s_add_u32 s5, s5, 57344
    v_add_u32 v2, s5, v2
    ds_read_b64 v[164:165], v2
    s_lshl_b32 s5, s46, 9
    s_add_u32 s5, s5, 53248
    v_add_u32 v3, s5, v13
    s_waitcnt lgkmcnt(0)
    v_and_b32 v204, v240, v164
    v_and_b32 v205, v241, v164
    v_and_b32 v206, v242, v164
    v_and_b32 v207, v243, v164
    v_and_b32 v208, v240, v165
    v_and_b32 v209, v241, v165
    v_and_b32 v210, v242, v165
    v_and_b32 v211, v243, v165
    v_mfma_f32_16x16x32_bf16 v[212:215], v[204:207], v[100:103], 0
    v_mfma_f32_16x16x32_bf16 v[216:219], v[204:207], v[104:107], 0
    s_nop 1
    v_mfma_f32_16x16x32_bf16 v[212:215], v[208:211], v[108:111], v[212:215]
    v_mfma_f32_16x16x32_bf16 v[216:219], v[208:211], v[112:115], v[216:219]
    s_nop 8
    s_and_b32 exec_lo, s100, 0xffff
    s_mov_b32 exec_hi, 0
    ds_write_b128 v3, v[212:215]
    ds_write_b128 v3, v[216:219] offset:256
    s_mov_b64 exec, s[100:101]
    s_waitcnt lgkmcnt(0)
    s_cmp_eq_u32 s100, 0
    s_cbranch_scc1 L_bar_82
    s_barrier
L_bar_82:
    s_cmp_lg_u32 s3, 4
    s_cbranch_scc1 L_final
    v_add_u32 v3, 53248, v13
    s_and_b32 exec_lo, s100, 0xffff
    s_mov_b32 exec_hi, 0
    ds_read_b128 v[20:23], v3 offset:0
    ds_read_b128 v[24:27], v3 offset:256
    ds_read_b128 v[28:31], v3 offset:512
    ds_read_b128 v[32:35], v3 offset:768
    ds_read_b128 v[36:39], v3 offset:1024
    ds_read_b128 v[40:43], v3 offset:1280
    ds_read_b128 v[44:47], v3 offset:1536
    ds_read_b128 v[48:51], v3 offset:1792
    s_waitcnt lgkmcnt(0)
    v_pk_add_f32 v[20:21], v[20:21], v[28:29]
    v_pk_add_f32 v[36:37], v[36:37], v[44:45]
    v_pk_add_f32 v[20:21], v[20:21], v[36:37]
    v_pk_add_f32 v[22:23], v[22:23], v[30:31]
    v_pk_add_f32 v[38:39], v[38:39], v[46:47]
    v_pk_add_f32 v[22:23], v[22:23], v[38:39]
    v_pk_add_f32 v[24:25], v[24:25], v[32:33]
    v_pk_add_f32 v[40:41], v[40:41], v[48:49]
    v_pk_add_f32 v[24:25], v[24:25], v[40:41]
    v_pk_add_f32 v[26:27], v[26:27], v[34:35]
    v_pk_add_f32 v[42:43], v[42:43], v[50:51]
    v_pk_add_f32 v[26:27], v[26:27], v[42:43]
    v_min_u32 v20, 0xfffffffe, v20
    v_min_u32 v21, 0xfffffffe, v21
    v_min_u32 v22, 0xfffffffe, v22
    v_min_u32 v23, 0xfffffffe, v23
    v_min_u32 v24, 0xfffffffe, v24
    v_min_u32 v25, 0xfffffffe, v25
    v_min_u32 v26, 0xfffffffe, v26
    v_min_u32 v27, 0xfffffffe, v27
    s_add_u32 s4, s4, 2048
    buffer_store_dwordx4 v[20:23], v13, s[8:11], s4 offen sc1
    buffer_store_dwordx4 v[24:27], v13, s[8:11], s4 offen offset:256 sc1
    s_mov_b64 exec, s[100:101]
    s_branch L_end
L_final:
    s_cmp_lg_u32 s3, 5
    s_cselect_b32 s99, s100, 0
    s_cmp_lg_u32 s99, 0
    s_cbranch_scc1 L_end
    s_cmp_ge_u32 s42, 10
    s_cselect_b32 s99, s100, 0
    s_cmp_lg_u32 s99, 0
    s_cbranch_scc1 L_end
    s_waitcnt vmcnt(0)
    s_lshl_b32 s4, s42, 6
    v_add_u32 v12, s4, v1
    v_lshlrev_b32 v2, 2, v12
    v_add_u32 v3, 45312, v2
    ds_read_b32 v10, v3
    v_lshrrev_b32 v4, 7, v12
    v_lshlrev_b32 v4, 9, v4
    v_and_b32 v5, 1, v12
    v_lshl_add_u32 v4, v5, 8, v4
    v_bfe_u32 v5, v12, 3, 4
    v_lshl_add_u32 v4, v5, 4, v4
    v_bfe_u32 v5, v12, 1, 2
    v_lshl_add_u32 v4, v5, 2, v4
    s_mul_i32 s4, s43, 15360
    s_add_u32 s4, s4, 20992
    s_mul_i32 s5, s43, 69120
    s_add_u32 s5, s5, 442368
    s_cbranch_execz L_spin_83_x
    s_mov_b32 s98, 0
L_spin_83:
    s_mov_b32 s6, s4
    buffer_load_dword v48, v2, s[8:11], s6 offen sc1
    s_add_u32 s6, s6, 30720
    buffer_load_dword v49, v2, s[8:11], s6 offen sc1
    s_add_u32 s6, s6, 30720
    buffer_load_dword v50, v2, s[8:11], s6 offen sc1
    s_add_u32 s6, s6, 30720
    buffer_load_dword v51, v2, s[8:11], s6 offen sc1
    s_waitcnt vmcnt(0)
    v_max3_u32 v6, v48, v49, v50
    v_max_u32 v6, v6, v51
    v_cmp_eq_u32 vcc, -1, v6
    s_cbranch_vccz L_spd_84
    s_add_u32 s98, s98, 1
    s_cmp_gt_u32 s98, 200000
    s_cbranch_scc1 L_end
    s_sleep 1
    s_branch L_spin_83
L_spd_84:
L_spin_83_x:
    s_add_u32 s48, s5, 0
    s_add_u32 s49, s5, 7680
    s_add_u32 s50, s5, 15360
    s_add_u32 s51, s5, 23040
    s_add_u32 s52, s5, 30720
    s_add_u32 s53, s5, 38400
    s_add_u32 s54, s5, 46080
    s_add_u32 s55, s5, 53760
    s_add_u32 s56, s5, 61440
    v_add_u32 v5, 5120, v4
    s_mov_b32 s98, 0
    buffer_load_dword v20, v4, s[8:11], s48 offen offset:0 sc1
    buffer_load_dword v21, v4, s[8:11], s48 offen offset:2560 sc1
    buffer_load_dword v22, v5, s[8:11], s48 offen sc1
    buffer_load_dword v23, v4, s[8:11], s49 offen offset:0 sc1
    buffer_load_dword v24, v4, s[8:11], s49 offen offset:2560 sc1
    buffer_load_dword v25, v5, s[8:11], s49 offen sc1
    buffer_load_dword v26, v4, s[8:11], s50 offen offset:0 sc1
    buffer_load_dword v27, v4, s[8:11], s50 offen offset:2560 sc1
    buffer_load_dword v28, v5, s[8:11], s50 offen sc1
    buffer_load_dword v29, v4, s[8:11], s51 offen offset:0 sc1
    buffer_load_dword v30, v4, s[8:11], s51 offen offset:2560 sc1
    buffer_load_dword v31, v5, s[8:11], s51 offen sc1
    buffer_load_dword v32, v4, s[8:11], s52 offen offset:0 sc1
    buffer_load_dword v33, v4, s[8:11], s52 offen offset:2560 sc1
    buffer_load_dword v34, v5, s[8:11], s52 offen sc1
    buffer_load_dword v35, v4, s[8:11], s53 offen offset:0 sc1
    buffer_load_dword v36, v4, s[8:11], s53 offen offset:2560 sc1
    buffer_load_dword v37, v5, s[8:11], s53 offen sc1
    buffer_load_dword v38, v4, s[8:11], s54 offen offset:0 sc1
    buffer_load_dword v39, v4, s[8:11], s54 offen offset:2560 sc1
    buffer_load_dword v40, v5, s[8:11], s54 offen sc1
    buffer_load_dword v41, v4, s[8:11], s55 offen offset:0 sc1
    buffer_load_dword v42, v4, s[8:11], s55 offen offset:2560 sc1
    buffer_load_dword v43, v5, s[8:11], s55 offen sc1
    buffer_load_dword v44, v4, s[8:11], s56 offen offset:0 sc1
    buffer_load_dword v45, v4, s[8:11], s56 offen offset:2560 sc1
    buffer_load_dword v46, v5, s[8:11], s56 offen sc1
    s_sleep 6
L_fin_top:
    buffer_load_dword v60, v4, s[8:11], s48 offen offset:0 sc1
    buffer_load_dword v61, v4, s[8:11], s48 offen offset:2560 sc1
    buffer_load_dword v62, v5, s[8:11], s48 offen sc1
    buffer_load_dword v63, v4, s[8:11], s49 offen offset:0 sc1
    buffer_load_dword v64, v4, s[8:11], s49 offen offset:2560 sc1
    buffer_load_dword v65, v5, s[8:11], s49 offen sc1
    buffer_load_dword v66, v4, s[8:11], s50 offen offset:0 sc1
    buffer_load_dword v67, v4, s[8:11], s50 offen offset:2560 sc1
    buffer_load_dword v68, v5, s[8:11], s50 offen sc1
    buffer_load_dword v69, v4, s[8:11], s51 offen offset:0 sc1
    buffer_load_dword v70, v4, s[8:11], s51 offen offset:2560 sc1
    buffer_load_dword v71, v5, s[8:11], s51 offen sc1
    buffer_load_dword v72, v4, s[8:11], s52 offen offset:0 sc1
    buffer_load_dword v73, v4, s[8:11], s52 offen offset:2560 sc1
    buffer_load_dword v74, v5, s[8:11], s52 offen sc1
    buffer_load_dword v75, v4, s[8:11], s53 offen offset:0 sc1
    buffer_load_dword v76, v4, s[8:11], s53 offen offset:2560 sc1
    buffer_load_dword v77, v5, s[8:11], s53 offen sc1
    buffer_load_dword v78, v4, s[8:11], s54 offen offset:0 sc1
    buffer_load_dword v79, v4, s[8:11], s54 offen offset:2560 sc1
    buffer_load_dword v80, v5, s[8:11], s54 offen sc1
    buffer_load_dword v81, v4, s[8:11], s55 offen offset:0 sc1
    buffer_load_dword v82, v4, s[8:11], s55 offen offset:2560 sc1
    buffer_load_dword v83, v5, s[8:11], s55 offen sc1
    buffer_load_dword v84, v4, s[8:11], s56 offen offset:0 sc1
    buffer_load_dword v85, v4, s[8:11], s56 offen offset:2560 sc1
    buffer_load_dword v86, v5, s[8:11], s56 offen sc1
    s_waitcnt vmcnt(27)
    v_max3_u32 v6, v20, v21, v22
    v_max3_u32 v6, v6, v23, v24
    v_max3_u32 v6, v6, v25, v26
    v_max3_u32 v6, v6, v27, v28
    v_max3_u32 v6, v6, v29, v30
    v_max3_u32 v6, v6, v31, v32
    v_max3_u32 v6, v6, v33, v34
    v_max3_u32 v6, v6, v35, v36
    v_max3_u32 v6, v6, v37, v38
    v_max3_u32 v6, v6, v39, v40
    v_max3_u32 v6, v6, v41, v42
    v_max3_u32 v6, v6, v43, v44
    v_max3_u32 v6, v6, v45, v46
    v_cmp_eq_u32 vcc, -1, v6
    s_cbranch_vccz L_fin_done
    buffer_load_dword v20, v4, s[8:11], s48 offen offset:0 sc1
    buffer_load_dword v21, v4, s[8:11], s48 offen offset:2560 sc1
    buffer_load_dword v22, v5, s[8:11], s48 offen sc1
    buffer_load_dword v23, v4, s[8:11], s49 offen offset:0 sc1
    buffer_load_dword v24, v4, s[8:11], s49 offen offset:2560 sc1
    buffer_load_dword v25, v5, s[8:11], s49 offen sc1
    buffer_load_dword v26, v4, s[8:11], s50 offen offset:0 sc1
    buffer_load_dword v27, v4, s[8:11], s50 offen offset:2560 sc1
    buffer_load_dword v28, v5, s[8:11], s50 offen sc1
    buffer_load_dword v29, v4, s[8:11], s51 offen offset:0 sc1
    buffer_load_dword v30, v4, s[8:11], s51 offen offset:2560 sc1
    buffer_load_dword v31, v5, s[8:11], s51 offen sc1
    buffer_load_dword v32, v4, s[8:11], s52 offen offset:0 sc1
    buffer_load_dword v33, v4, s[8:11], s52 offen offset:2560 sc1
    buffer_load_dword v34, v5, s[8:11], s52 offen sc1
    buffer_load_dword v35, v4, s[8:11], s53 offen offset:0 sc1
    buffer_load_dword v36, v4, s[8:11], s53 offen offset:2560 sc1
    buffer_load_dword v37, v5, s[8:11], s53 offen sc1
    buffer_load_dword v38, v4, s[8:11], s54 offen offset:0 sc1
    buffer_load_dword v39, v4, s[8:11], s54 offen offset:2560 sc1
    buffer_load_dword v40, v5, s[8:11], s54 offen sc1
    buffer_load_dword v41, v4, s[8:11], s55 offen offset:0 sc1
    buffer_load_dword v42, v4, s[8:11], s55 offen offset:2560 sc1
    buffer_load_dword v43, v5, s[8:11], s55 offen sc1
    buffer_load_dword v44, v4, s[8:11], s56 offen offset:0 sc1
    buffer_load_dword v45, v4, s[8:11], s56 offen offset:2560 sc1
    buffer_load_dword v46, v5, s[8:11], s56 offen sc1
    s_waitcnt vmcnt(27)
    v_max3_u32 v6, v60, v61, v62
    v_max3_u32 v6, v6, v63, v64
    v_max3_u32 v6, v6, v65, v66
    v_max3_u32 v6, v6, v67, v68
    v_max3_u32 v6, v6, v69, v70
    v_max3_u32 v6, v6, v71, v72
    v_max3_u32 v6, v6, v73, v74
    v_max3_u32 v6, v6, v75, v76
    v_max3_u32 v6, v6, v77, v78
    v_max3_u32 v6, v6, v79, v80
    v_max3_u32 v6, v6, v81, v82
    v_max3_u32 v6, v6, v83, v84
    v_max3_u32 v6, v6, v85, v86
    v_cmp_eq_u32 vcc, -1, v6
    s_cbranch_vccz L_fin_b
    s_add_u32 s98, s98, 1
    s_cmp_gt_u32 s98, 200000
    s_cbranch_scc1 L_end
    s_branch L_fin_top
L_fin_b:
    s_waitcnt vmcnt(0)
    v_mov_b32 v20, v60
    v_mov_b32 v21, v61
    v_mov_b32 v22, v62
    v_mov_b32 v23, v63
    v_mov_b32 v24, v64
    v_mov_b32 v25, v65
    v_mov_b32 v26, v66
    v_mov_b32 v27, v67
    v_mov_b32 v28, v68
    v_mov_b32 v29, v69
    v_mov_b32 v30, v70
    v_mov_b32 v31, v71
    v_mov_b32 v32, v72
    v_mov_b32 v33, v73
    v_mov_b32 v34, v74
    v_mov_b32 v35, v75
    v_mov_b32 v36, v76
    v_mov_b32 v37, v77
    v_mov_b32 v38, v78
    v_mov_b32 v39, v79
    v_mov_b32 v40, v80
    v_mov_b32 v41, v81
    v_mov_b32 v42, v82
    v_mov_b32 v43, v83
    v_mov_b32 v44, v84
    v_mov_b32 v45, v85
    v_mov_b32 v46, v86
L_fin_done:
    v_add_f32 v11, v48, v49
    v_add_f32 v50, v50, v51
    v_add_f32 v11, v11, v50
    v_cvt_pk_bf16_f32 v11, v11, v11
    v_and_b32 v11, 0xffff0000, v11
    v_add_f32 v20, v20, v21
    v_add_f32 v20, v20, v22
    v_add_f32 v20, v20, v23
    v_add_f32 v20, v20, v24
    v_add_f32 v20, v20, v25
    v_add_f32 v20, v20, v26
    v_add_f32 v20, v20, v27
    v_add_f32 v20, v20, v28
    v_add_f32 v20, v20, v29
    v_add_f32 v20, v20, v30
    v_add_f32 v20, v20, v31
    v_add_f32 v20, v20, v32
    v_add_f32 v20, v20, v33
    v_add_f32 v20, v20, v34
    v_add_f32 v20, v20, v35
    v_add_f32 v20, v20, v36
    v_add_f32 v20, v20, v37
    v_add_f32 v20, v20, v38
    v_add_f32 v20, v20, v39
    v_add_f32 v20, v20, v40
    v_add_f32 v20, v20, v41
    v_add_f32 v20, v20, v42
    v_add_f32 v20, v20, v43
    v_add_f32 v20, v20, v44
    v_add_f32 v20, v20, v45
    v_add_f32 v20, v20, v46
    v_cvt_pk_bf16_f32 v20, v20, v20
    v_and_b32 v20, 0xffff0000, v20
    v_mul_f32 v20, v11, v20
    v_cvt_pk_bf16_f32 v20, v20, v20
    v_and_b32 v20, 0xffff0000, v20
    s_waitcnt lgkmcnt(0)
    v_add_f32 v20, v10, v20
    v_cvt_pk_bf16_f32 v20, v20, v20
    v_lshlrev_b32 v2, 1, v12
    s_mul_i32 s4, s43, 1280
    buffer_store_short v20, v2, s[36:39], s4 offen
    s_cmp_lg_u32 s100, 0
    s_cbranch_scc1 L_end
    s_mov_b64 s[100:101], -1
    s_mov_b64 exec, -1
    s_branch L_e_main
L_end:
    s_endpgm
.section .rodata,"a"
.p2align 6
.amdhsa_kernel adaLN_cond__compressed_kv_cla__glu_gated_glu__decode_kernel
  .amdhsa_next_free_vgpr 256
  .amdhsa_next_free_sgpr 102
  .amdhsa_accum_offset 256
  .amdhsa_group_segment_fixed_size 0
  .amdhsa_kernarg_size 120
  .amdhsa_user_sgpr_count 2
  .amdhsa_user_sgpr_kernarg_segment_ptr 1
  .amdhsa_system_sgpr_workgroup_id_x 1
.end_amdhsa_kernel
```
